```python
import torch

def _softmax(x, axis=-1):
    return torch.softmax(x, dim=axis)
def _gelu(x):
    return torch.nn.functional.gelu(x, approximate="tanh")
def _silu(x):
    return torch.nn.functional.silu(x)
def _sigmoid(x):
    return torch.sigmoid(x)
def _layernorm(x, axis=-1, eps=1e-5):
    m = x.mean(dim=axis, keepdim=True)
    v = x.var(dim=axis, keepdim=True, unbiased=False)
    return (x - m) / torch.sqrt(v + eps)
def _scatter_add(tgt, idx, src, axis=0):
    return tgt.clone().index_add_(axis, idx, src)
def _segment_sum(src, seg, n):
    out = torch.zeros((n,) + src.shape[1:], dtype=src.dtype)
    return out.index_add_(0, seg, src)
def _pad(x, pw):
    flat = tuple(v for pair in reversed(pw) for v in pair)
    return torch.nn.functional.pad(x, flat)

kernel_name = 'standalone__ssm_conv_s4d__prompt'

def setup_inputs():

    _w = (lambda a: (lambda t: t.to(torch.bfloat16) if t.is_floating_point() else t)(torch.as_tensor(a)))
    Bsz, L, D, N = 1, 2048, 448, 256
    return {
        "u": _w((lambda *s: torch.randn(*s, dtype=torch.bfloat16) * 0.05)(Bsz, L, D)),
        "log_A_real": _w((lambda *s: torch.randn(*s, dtype=torch.bfloat16) * 6.4)(D, N) * 0.5),
        "A_imag": _w((lambda *s: torch.randn(*s, dtype=torch.bfloat16) * 0.05)(D, N) * 3.14),
        "C_real": _w((lambda *s: torch.randn(*s, dtype=torch.bfloat16) * 0.05)(D, N) / N ** 0.5),
        "C_imag": _w((lambda *s: torch.randn(*s, dtype=torch.bfloat16) * 0.05)(D, N) / N ** 0.5),
        "log_dt": _w((lambda *s: torch.randn(*s, dtype=torch.bfloat16) * 0.05)(D) * 0.5 - 4.0),
        "D_skip": _w((lambda *s: torch.randn(*s, dtype=torch.bfloat16) * 0.05)(D)),
    }

def reference(u, log_A_real, A_imag, C_real, C_imag, log_dt, D_skip):
    L = u.shape[1]
    dt = torch.exp(log_dt)
    A = -torch.exp(log_A_real) + 1j * A_imag
    C = (C_real + 1j * C_imag) * dt[:, None]
    pos = (lambda x, dt: x.to(dt))(torch.arange(L), log_dt.dtype)
    P = torch.exp((A * dt[:, None])[:, :, None] * pos[None, None, :])
    K = 2.0 * torch.einsum("dn,dnl->dl", C, P).real
    L2 = 2 * L
    u_t = (lambda x, *d: x.permute(*d))(u, 0, 2, 1)
    Kf = (lambda x, *a, **k: torch.fft.rfft(x.float(), *a, **k))(K, L2)
    Uf = (lambda x, *a, **k: torch.fft.rfft(x.float(), *a, **k))(u_t, L2)
    y = (lambda x, *a, **k: torch.fft.irfft(x, *a, **k).to(torch.bfloat16))(Uf * Kf[None, :, :], L2)[:, :, :L]
    y = (lambda x, *d: x.permute(*d))(y, 0, 2, 1)
    return y + u * D_skip[None, None, :]
```

```asm
; @launch grid=(256,1,1) block=(512,1,1) lds=121600
.amdgcn_target "amdgcn-amd-amdhsa--gfx950"
.text
.globl standalone__ssm_conv_s4d__prompt_kernel
.p2align 8
.type standalone__ssm_conv_s4d__prompt_kernel,@function
standalone__ssm_conv_s4d__prompt_kernel:
    s_getpc_b64 s[52:53]
L_pc:
    v_lshrrev_b32 v2, 6, v0
    s_and_b32 s34, s2, 0x78
    s_load_dwordx16 s[4:19], s[0:1], 0
    v_add_lshl_u32 v4, v2, s34, 7
    global_load_dword v253, v4, s[52:53]
    v_readfirstlane_b32 s28, v2
    s_and_b32 s33, s2, 7
    s_cmp_eq_u32 s33, 7
    s_cbranch_scc1 L_end
    s_cmp_ge_u32 s2, 256
    s_cbranch_scc1 L_end
    v_and_b32 v1, 63, v0
    s_add_u32 s52, s52, L_tab-L_pc
    s_addc_u32 s53, s53, 0
    v_lshlrev_b32 v3, 4, v1
    global_load_dwordx4 v[20:23], v3, s[52:53]
    global_load_dwordx4 v[24:27], v3, s[52:53] offset:1024
    s_lshr_b32 s34, s2, 4
    s_lshl_b32 s32, s33, 4
    s_add_u32 s32, s32, s34
    s_and_b32 s29, s28, 3
    s_lshr_b32 s30, s28, 2
    s_lshl_b32 s35, s32, 3
    s_lshl_b32 s33, s29, 1
    s_add_u32 s33, s33, s35
    s_add_u32 s33, s33, s30
    s_lshl_b32 s33, s33, 8
    v_lshl_add_u32 v5, v1, 1, s33
    v_mov_b32 v60, 0
    v_mov_b32 v61, 0
    v_mov_b32 v56, 0
    v_mov_b32 v57, 0
    v_mov_b32 v218, 0
    v_mov_b32 v219, 0
    v_mov_b32 v214, 0
    v_mov_b32 v215, 0
    s_bfe_u32 s31, s2, 0x10003
    s_mov_b32 s23, 0x00020000
    s_mov_b32 s26, 1835008
    s_cmp_eq_u32 s31, 0
    s_cselect_b32 s22, s26, 1261568
    s_waitcnt lgkmcnt(0)
    global_load_short_d16_hi v60, v5, s[6:7]
    global_load_short_d16_hi v61, v5, s[8:9]
    s_load_dwordx2 s[36:37], s[14:15], s35
    s_load_dwordx2 s[38:39], s[16:17], s35
    global_load_short_d16_hi v56, v5, s[10:11]
    global_load_short_d16_hi v57, v5, s[12:13]
    global_load_short_d16_hi v214, v5, s[10:11] offset:128
    global_load_short_d16_hi v215, v5, s[12:13] offset:128
    global_load_short_d16_hi v218, v5, s[6:7] offset:128
    global_load_short_d16_hi v219, v5, s[8:9] offset:128
    s_mov_b32 s20, s4
    s_mov_b32 s21, s5
    s_cmp_eq_u32 s30, 0
    s_cbranch_scc1 L_nopf
    s_and_b32 s33, s2, 0xf8
    s_lshr_b32 s33, s33, 1
    s_add_u32 s33, s33, s29
    s_mul_i32 s33, s33, 14336
    s_add_u32 s33, s33, s35
    v_and_b32 v4, 15, v1
    s_movk_i32 s34, 896
    v_mul_u32_u24 v4, s34, v4
    v_add_u32 v4, s33, v4
    global_load_dword v254, v4, s[4:5]
    s_barrier
    v_mov_b32 v28, 0
    v_mov_b32 v31, 0
    s_mov_b32 s24, s18
    s_mov_b32 s25, s19
    s_mov_b32 s27, 0x00020000
    s_mul_i32 s33, s29, 4736
    s_add_u32 s33, s33, 40960
    s_mov_b32 m0, s33
    v_mov_b32 v44, 0
    s_mul_i32 s33, s29, 4160
    s_add_u32 s33, s33, 40960
    ds_write_addtid_b32 v44 offset:45056
    ds_write_addtid_b32 v44 offset:46240
    ds_write_addtid_b32 v44 offset:47424
    ds_write_addtid_b32 v44 offset:48608
    s_mov_b32 m0, s33
    s_nop 0
    ds_write_addtid_b32 v44 offset:63808
    s_branch L_nou
L_nopf:
    s_mul_i32 s33, s29, 114688
    s_add_u32 s33, s33, s35
    s_movk_i32 s34, 1792
    v_mul_u32_u24 v28, s34, v1
    v_add_u32 v28, s33, v28
    s_mov_b32 s48, 458752
    s_lshl_b32 s33, s29, 6
    v_add_u32 v45, s33, v1
    s_mov_b32 s33, 21504
    v_lshl_add_u32 v29, v45, 2, s33
    s_mov_b32 s33, 104640
    v_lshl_add_u32 v30, v45, 1, s33
    s_movk_i32 s33, 896
    v_mul_u32_u24 v31, s33, v45
    v_add_u32 v31, s35, v31
    s_mov_b32 s24, s18
    s_mov_b32 s25, s19
    s_mov_b32 s27, 0x00020000
    s_barrier
    buffer_load_dwordx2 v[226:227], v28, s[20:23], 0 offen
    buffer_load_dwordx2 v[228:229], v28, s[20:23], 0 offen offset:896
    buffer_load_dwordx2 v[230:231], v28, s[20:23], s48 offen
    buffer_load_dwordx2 v[232:233], v28, s[20:23], s48 offen offset:896
L_nou:
    s_mul_i32 s40, s28, 5376
    s_mov_b32 m0, s40
    v_mov_b32 v44, 0x3c00
    s_mov_b32 s49, 917504
    ds_write_addtid_b32 v44 offset:1088
    s_mov_b32 s54, 1376256
    s_mul_i32 s43, s29, 5376
    s_add_u32 s42, s43, 21504
    s_mul_i32 s41, s29, 4736
    s_add_u32 s3, s41, 40960
    s_mul_i32 s34, s29, 4160
    v_mov_b32 v46, 0x3fb8aa3b
    v_mov_b32 v45, 0x3e22f983
    v_mov_b32 v47, 0x31dc9c88
    s_lshl_b32 s33, s29, 4
    s_waitcnt lgkmcnt(0)
    s_lshr_b64 s[36:37], s[36:37], s33
    s_lshl_b32 s36, s36, 16
    v_mul_f32 v18, s36, v46
    v_exp_f32 v18, v18
    s_nop 0
    v_cvt_pk_bf16_f32 v18, 0, v18
    v_mul_f32 v14, 0xbfb8aa3b, v18
    v_mul_f32 v15, v45, v18
    v_fma_f32 v16, v18, v45, -v15
    v_fmac_f32 v16, v18, v47
    s_waitcnt vmcnt(4)
    s_cmp_eq_u32 s30, 0
    s_cbranch_scc1 L_w7
    s_waitcnt vmcnt(1)
L_w7:
    s_setprio 3
    v_max3_f32 v176, |v56|, |v57|, |v214|
    v_mul_f32 v60, 0x3fb8aa3b, v60
    v_max_f32 v176, v176, |v215|
    v_mul_f32 v62, v61, v15
    v_exp_f32 v60, v60
    v_max_u32_dpp v176, v176, v176 row_shr:1 row_mask:0xf bank_mask:0xf
    v_rndne_f32 v62, v62
    v_cvt_pk_bf16_f32 v60, 0, v60
    v_max_u32_dpp v176, v176, v176 row_shr:2 row_mask:0xf bank_mask:0xf
    v_fma_f32 v62, v61, v15, -v62
    v_mul_f32 v60, v60, v14
    v_fmac_f32 v62, v61, v16
    v_max_u32_dpp v176, v176, v176 row_shr:4 row_mask:0xf bank_mask:0xf
    v_exp_f32 v60, v60
    v_cos_f32 v34, v62
    v_sin_f32 v35, v62
    v_max_u32_dpp v176, v176, v176 row_shr:8 row_mask:0xf bank_mask:0xf
    v_pk_mul_f32 v[34:35], v[34:35], v[60:61] op_sel:[0,0] op_sel_hi:[1,0]
    v_add_u32 v20, s40, v20
    v_max_u32_dpp v176, v176, v176 row_bcast:15 row_mask:0xa bank_mask:0xf
    v_pk_mul_f32 v[36:37], v[34:35], v[34:35] op_sel:[0,0] op_sel_hi:[1,0]
    v_cvt_pk_f16_f32 v64, v34, v35
    v_pk_fma_f32 v[36:37], v[34:35], v[34:35], v[36:37] op_sel:[1,1,0] op_sel_hi:[0,1,1] neg_lo:[1,0,0]
    v_max_u32_dpp v176, v176, v176 row_bcast:31 row_mask:0xc bank_mask:0xf
    v_pk_mul_f32 v[38:39], v[36:37], v[36:37] op_sel:[0,0] op_sel_hi:[1,0]
    v_readlane_b32 s33, v176, 63
    v_pk_fma_f32 v[38:39], v[36:37], v[36:37], v[38:39] op_sel:[1,1,0] op_sel_hi:[0,1,1] neg_lo:[1,0,0]
    s_nop 0
    s_lshr_b32 s33, s33, 23
    v_pk_mul_f32 v[40:41], v[38:39], v[38:39] op_sel:[0,0] op_sel_hi:[1,0]
    s_sub_u32 s33, 267, s33
    v_pk_fma_f32 v[40:41], v[38:39], v[38:39], v[40:41] op_sel:[1,1,0] op_sel_hi:[0,1,1] neg_lo:[1,0,0]
    s_min_u32 s33, s33, 253
    v_pk_mul_f32 v[42:43], v[40:41], v[40:41] op_sel:[0,0] op_sel_hi:[1,0]
    s_lshl_b32 s44, s33, 23
    s_sub_u32 s33, 255, s33
    v_pk_fma_f32 v[42:43], v[40:41], v[40:41], v[42:43] op_sel:[1,1,0] op_sel_hi:[0,1,1] neg_lo:[1,0,0]
    s_lshl_b32 s45, s33, 23
    v_pk_mul_f32 v[46:47], v[42:43], v[42:43] op_sel:[0,0] op_sel_hi:[1,0]
    v_pk_mul_f32 v[56:57], v[56:57], s[44:45] op_sel:[0,0] op_sel_hi:[1,0] neg_hi:[0,1]
    v_pk_fma_f32 v[46:47], v[42:43], v[42:43], v[46:47] op_sel:[1,1,0] op_sel_hi:[0,1,1] neg_lo:[1,0,0]
    v_cvt_pk_f16_f32 v81, v56, v57
    v_pk_mul_f32 v[48:49], v[46:47], v[46:47] op_sel:[0,0] op_sel_hi:[1,0]
    v_pk_mul_f16 v82, v81, v64 op_sel:[0,0] op_sel_hi:[1,0]
    v_pk_fma_f32 v[48:49], v[46:47], v[46:47], v[48:49] op_sel:[1,1,0] op_sel_hi:[0,1,1] neg_lo:[1,0,0]
    v_cvt_pk_f16_f32 v65, v36, v37
    v_cvt_pk_f16_f32 v67, v40, v41
    v_cvt_pk_f16_f32 v68, v42, v43
    v_cvt_pk_f16_f32 v70, v46, v47
    v_cvt_pk_f16_f32 v71, v48, v49
    v_pk_fma_f16 v82, v81, v64, v82 op_sel:[1,1,0] op_sel_hi:[0,1,1] neg_hi:[1,0,0]
    v_pk_mul_f16 v69, v67, v68 op_sel:[0,0] op_sel_hi:[1,0]
    v_pk_mul_f16 v72, v70, v71 op_sel:[0,0] op_sel_hi:[1,0]
    v_pk_mul_f16 v83, v81, v65 op_sel:[0,0] op_sel_hi:[1,0]
    v_pk_mul_f16 v84, v82, v65 op_sel:[0,0] op_sel_hi:[1,0]
    v_pk_mul_f32 v[52:53], v[48:49], v[48:49] op_sel:[0,0] op_sel_hi:[1,0]
    v_cvt_pk_f16_f32 v66, v38, v39
    v_pk_fma_f16 v69, v67, v68, v69 op_sel:[1,1,0] op_sel_hi:[0,1,1] neg_lo:[1,0,0]
    v_pk_fma_f16 v72, v70, v71, v72 op_sel:[1,1,0] op_sel_hi:[0,1,1] neg_lo:[1,0,0]
    v_pk_fma_f16 v83, v81, v65, v83 op_sel:[1,1,0] op_sel_hi:[0,1,1] neg_hi:[1,0,0]
    v_pk_fma_f16 v84, v82, v65, v84 op_sel:[1,1,0] op_sel_hi:[0,1,1] neg_hi:[1,0,0]
    v_pk_fma_f32 v[52:53], v[48:49], v[48:49], v[52:53] op_sel:[1,1,0] op_sel_hi:[0,1,1] neg_lo:[1,0,0]
    v_pk_mul_f16 v74, v67, v70 op_sel:[0,0] op_sel_hi:[1,0]
    v_pk_mul_f16 v75, v68, v70 op_sel:[0,0] op_sel_hi:[1,0]
    v_pk_mul_f16 v76, v69, v70 op_sel:[0,0] op_sel_hi:[1,0]
    v_pk_mul_f16 v77, v67, v71 op_sel:[0,0] op_sel_hi:[1,0]
    v_pk_mul_f16 v78, v68, v71 op_sel:[0,0] op_sel_hi:[1,0]
    v_pk_mul_f16 v79, v69, v71 op_sel:[0,0] op_sel_hi:[1,0]
    v_pk_mul_f16 v80, v67, v72 op_sel:[0,0] op_sel_hi:[1,0]
    v_pk_mul_f16 v6, v68, v72 op_sel:[0,0] op_sel_hi:[1,0]
    v_pk_mul_f16 v7, v69, v72 op_sel:[0,0] op_sel_hi:[1,0]
    v_pk_mul_f16 v89, v81, v66 op_sel:[0,0] op_sel_hi:[1,0]
    v_pk_mul_f16 v90, v82, v66 op_sel:[0,0] op_sel_hi:[1,0]
    v_pk_mul_f16 v91, v83, v66 op_sel:[0,0] op_sel_hi:[1,0]
    v_pk_mul_f16 v92, v84, v66 op_sel:[0,0] op_sel_hi:[1,0]
    v_pk_mul_f32 v[54:55], v[52:53], v[52:53] op_sel:[0,0] op_sel_hi:[1,0]
    v_cvt_pk_f16_f32 v73, v52, v53
    v_pk_fma_f16 v74, v67, v70, v74 op_sel:[1,1,0] op_sel_hi:[0,1,1] neg_lo:[1,0,0]
    v_pk_fma_f16 v75, v68, v70, v75 op_sel:[1,1,0] op_sel_hi:[0,1,1] neg_lo:[1,0,0]
    v_pk_fma_f16 v76, v69, v70, v76 op_sel:[1,1,0] op_sel_hi:[0,1,1] neg_lo:[1,0,0]
    v_pk_fma_f16 v77, v67, v71, v77 op_sel:[1,1,0] op_sel_hi:[0,1,1] neg_lo:[1,0,0]
    v_pk_fma_f16 v78, v68, v71, v78 op_sel:[1,1,0] op_sel_hi:[0,1,1] neg_lo:[1,0,0]
    v_pk_fma_f16 v79, v69, v71, v79 op_sel:[1,1,0] op_sel_hi:[0,1,1] neg_lo:[1,0,0]
    v_pk_fma_f16 v80, v67, v72, v80 op_sel:[1,1,0] op_sel_hi:[0,1,1] neg_lo:[1,0,0]
    v_pk_fma_f16 v6, v68, v72, v6 op_sel:[1,1,0] op_sel_hi:[0,1,1] neg_lo:[1,0,0]
    v_pk_fma_f16 v7, v69, v72, v7 op_sel:[1,1,0] op_sel_hi:[0,1,1] neg_lo:[1,0,0]
    v_pk_fma_f16 v89, v81, v66, v89 op_sel:[1,1,0] op_sel_hi:[0,1,1] neg_hi:[1,0,0]
    v_pk_fma_f16 v90, v82, v66, v90 op_sel:[1,1,0] op_sel_hi:[0,1,1] neg_hi:[1,0,0]
    v_pk_fma_f16 v91, v83, v66, v91 op_sel:[1,1,0] op_sel_hi:[0,1,1] neg_hi:[1,0,0]
    v_pk_fma_f16 v92, v84, v66, v92 op_sel:[1,1,0] op_sel_hi:[0,1,1] neg_hi:[1,0,0]
    v_mul_f32 v18, s45, v18
    v_add_u32 v21, s40, v21
    v_add_u32 v22, s40, v22
    v_add_u32 v23, s40, v23
    v_pk_fma_f32 v[54:55], v[52:53], v[52:53], v[54:55] op_sel:[1,1,0] op_sel_hi:[0,1,1] neg_lo:[1,0,0]
    ds_write_addtid_b32 v67 offset:1360
    s_cmp_eq_u32 s30, 0
    s_cbranch_scc0 L_nu0
    buffer_load_dwordx2 v[234:235], v28, s[20:23], s49 offen
L_nu0:
    s_setprio 2
    ds_write_addtid_b32 v68 offset:1632
    ds_write_addtid_b32 v69 offset:1904
    ds_write_addtid_b32 v70 offset:0
    ds_write_addtid_b32 v71 offset:2176
    ds_write_addtid_b32 v72 offset:3264
    ds_write_addtid_b32 v73 offset:43280
    ds_write_addtid_b32 v74 offset:272
    ds_write_addtid_b32 v75 offset:544
    ds_write_addtid_b32 v76 offset:816
    ds_write_addtid_b32 v77 offset:2448
    ds_write_addtid_b32 v78 offset:2720
    ds_write_addtid_b32 v79 offset:2992
    ds_write_addtid_b32 v80 offset:3536
    ds_write_addtid_b32 v6 offset:3808
    ds_write_addtid_b32 v7 offset:4080
    ds_write_addtid_b32 v81 offset:43824
    ds_write_addtid_b32 v82 offset:45728
    ds_write_addtid_b32 v83 offset:45184
    ds_write_addtid_b32 v89 offset:4624
    ds_write_addtid_b32 v84 offset:46816
    ds_write_addtid_b32 v90 offset:43552
    ds_write_addtid_b32 v91 offset:4352
    ds_write_addtid_b32 v92 offset:44640
    ds_read_b128 v[112:115], v22 offset:0
    ds_read_b128 v[128:131], v23 offset:0
    ds_read_b128 v[116:119], v22 offset:16
    ds_read_b128 v[132:135], v23 offset:16
    ds_read_b128 v[120:123], v22 offset:32
    ds_read_b128 v[136:139], v23 offset:32
    ds_read_b128 v[124:127], v22 offset:48
    ds_read_b128 v[140:143], v23 offset:48
    v_pk_mul_f32 v[58:59], v[56:57], v[54:55] op_sel:[0,0] op_sel_hi:[1,0]
    v_mul_f32 v218, 0x3fb8aa3b, v218
    v_pk_fma_f32 v[58:59], v[56:57], v[54:55], v[58:59] op_sel:[1,1,0] op_sel_hi:[0,1,1] neg_hi:[1,0,0]
    v_mul_f32 v220, v219, v15
    v_pk_mul_f32 v[56:57], v[58:59], v[54:55] op_sel:[0,0] op_sel_hi:[1,0]
    v_cvt_pk_f16_f32 v85, v58, v59
    v_exp_f32 v218, v218
    v_pk_fma_f32 v[56:57], v[58:59], v[54:55], v[56:57] op_sel:[1,1,0] op_sel_hi:[0,1,1] neg_hi:[1,0,0]
    v_rndne_f32 v220, v220
    v_pk_mul_f16 v86, v85, v65 op_sel:[0,0] op_sel_hi:[1,0]
    v_pk_mul_f32 v[58:59], v[56:57], v[54:55] op_sel:[0,0] op_sel_hi:[1,0]
    v_cvt_pk_bf16_f32 v218, 0, v218
    v_cvt_pk_f16_f32 v87, v56, v57
    v_fma_f32 v220, v219, v15, -v220
    v_pk_fma_f32 v[58:59], v[56:57], v[54:55], v[58:59] op_sel:[1,1,0] op_sel_hi:[0,1,1] neg_hi:[1,0,0]
    v_pk_fma_f16 v86, v85, v65, v86 op_sel:[1,1,0] op_sel_hi:[0,1,1] neg_hi:[1,0,0]
    v_mul_f32 v218, v218, v14
    v_pk_mul_f32 v[56:57], v[58:59], v[54:55] op_sel:[0,0] op_sel_hi:[1,0]
    v_fmac_f32 v220, v219, v16
    v_cvt_pk_f16_f32 v88, v58, v59
    v_exp_f32 v218, v218
    v_pk_fma_f32 v[56:57], v[58:59], v[54:55], v[56:57] op_sel:[1,1,0] op_sel_hi:[0,1,1] neg_hi:[1,0,0]
    v_pk_mul_f16 v93, v85, v66 op_sel:[0,0] op_sel_hi:[1,0]
    v_cos_f32 v192, v220
    v_pk_mul_f32 v[58:59], v[56:57], v[54:55] op_sel:[0,0] op_sel_hi:[1,0]
    v_sin_f32 v193, v220
    v_cvt_pk_f16_f32 v9, v56, v57
    s_setprio 1
    v_pk_fma_f32 v[58:59], v[56:57], v[54:55], v[58:59] op_sel:[1,1,0] op_sel_hi:[0,1,1] neg_hi:[1,0,0]
    v_pk_mul_f32 v[214:215], v[214:215], s[44:45] op_sel:[0,0] op_sel_hi:[1,0] neg_hi:[0,1]
    v_pk_mul_f16 v94, v86, v66 op_sel:[0,0] op_sel_hi:[1,0]
    v_pk_mul_f32 v[192:193], v[192:193], v[218:219] op_sel:[0,0] op_sel_hi:[1,0]
    v_pk_mul_f32 v[56:57], v[58:59], v[54:55] op_sel:[0,0] op_sel_hi:[1,0]
    v_cvt_pk_f16_f32 v10, v58, v59
    v_pk_mul_f32 v[194:195], v[192:193], v[192:193] op_sel:[0,0] op_sel_hi:[1,0]
    v_pk_fma_f32 v[56:57], v[58:59], v[54:55], v[56:57] op_sel:[1,1,0] op_sel_hi:[0,1,1] neg_hi:[1,0,0]
    v_cvt_pk_f16_f32 v222, v192, v193
    v_pk_mul_f16 v95, v87, v66 op_sel:[0,0] op_sel_hi:[1,0]
    v_pk_mul_f32 v[58:59], v[56:57], v[54:55] op_sel:[0,0] op_sel_hi:[1,0]
    v_pk_fma_f32 v[194:195], v[192:193], v[192:193], v[194:195] op_sel:[1,1,0] op_sel_hi:[0,1,1] neg_lo:[1,0,0]
    v_cvt_pk_f16_f32 v11, v56, v57
    v_pk_mul_f32 v[196:197], v[194:195], v[194:195] op_sel:[0,0] op_sel_hi:[1,0]
    v_pk_fma_f32 v[58:59], v[56:57], v[54:55], v[58:59] op_sel:[1,1,0] op_sel_hi:[0,1,1] neg_hi:[1,0,0]
    v_pk_mul_f16 v8, v88, v66 op_sel:[0,0] op_sel_hi:[1,0]
    v_cvt_pk_f16_f32 v223, v194, v195
    v_pk_mul_f32 v[56:57], v[58:59], v[54:55] op_sel:[0,0] op_sel_hi:[1,0]
    v_pk_fma_f32 v[196:197], v[194:195], v[194:195], v[196:197] op_sel:[1,1,0] op_sel_hi:[0,1,1] neg_lo:[1,0,0]
    v_cvt_pk_f16_f32 v12, v58, v59
    v_pk_fma_f32 v[56:57], v[58:59], v[54:55], v[56:57] op_sel:[1,1,0] op_sel_hi:[0,1,1] neg_hi:[1,0,0]
    v_pk_mul_f32 v[198:199], v[196:197], v[196:197] op_sel:[0,0] op_sel_hi:[1,0]
    v_pk_fma_f16 v93, v85, v66, v93 op_sel:[1,1,0] op_sel_hi:[0,1,1] neg_hi:[1,0,0]
    v_cvt_pk_f16_f32 v224, v196, v197
    v_cvt_pk_f16_f32 v13, v56, v57
    v_pk_fma_f16 v94, v86, v66, v94 op_sel:[1,1,0] op_sel_hi:[0,1,1] neg_hi:[1,0,0]
    v_pk_fma_f32 v[198:199], v[196:197], v[196:197], v[198:199] op_sel:[1,1,0] op_sel_hi:[0,1,1] neg_lo:[1,0,0]
    v_pk_fma_f16 v95, v87, v66, v95 op_sel:[1,1,0] op_sel_hi:[0,1,1] neg_hi:[1,0,0]
    v_pk_mul_f32 v[200:201], v[198:199], v[198:199] op_sel:[0,0] op_sel_hi:[1,0]
    v_pk_fma_f16 v8, v88, v66, v8 op_sel:[1,1,0] op_sel_hi:[0,1,1] neg_hi:[1,0,0]
    v_pk_fma_f32 v[200:201], v[198:199], v[198:199], v[200:201] op_sel:[1,1,0] op_sel_hi:[0,1,1] neg_lo:[1,0,0]
    v_pk_mul_f32 v[204:205], v[200:201], v[200:201] op_sel:[0,0] op_sel_hi:[1,0]
    v_pk_fma_f32 v[204:205], v[200:201], v[200:201], v[204:205] op_sel:[1,1,0] op_sel_hi:[0,1,1] neg_lo:[1,0,0]
    ds_write_addtid_b32 v85 offset:47088
    ds_write_addtid_b32 v87 offset:44368
    ds_write_addtid_b32 v88 offset:47632
    ds_write_addtid_b32 v9 offset:45456
    v_pk_mul_f32 v[206:207], v[204:205], v[204:205] op_sel:[0,0] op_sel_hi:[1,0]
    s_cmp_eq_u32 s30, 0
    s_cbranch_scc0 L_nu1
    buffer_load_dwordx2 v[236:237], v28, s[20:23], s49 offen offset:896
L_nu1:
    v_pk_fma_f32 v[206:207], v[204:205], v[204:205], v[206:207] op_sel:[1,1,0] op_sel_hi:[0,1,1] neg_lo:[1,0,0]
    ds_write_addtid_b32 v10 offset:46000
    ds_write_addtid_b32 v11 offset:43008
    ds_write_addtid_b32 v12 offset:4896
    ds_write_addtid_b32 v13 offset:44912
    v_pk_mul_f32 v[210:211], v[206:207], v[206:207] op_sel:[0,0] op_sel_hi:[1,0]
    v_pk_fma_f32 v[210:211], v[206:207], v[206:207], v[210:211] op_sel:[1,1,0] op_sel_hi:[0,1,1] neg_lo:[1,0,0]
    v_pk_mul_f32 v[212:213], v[210:211], v[210:211] op_sel:[0,0] op_sel_hi:[1,0]
    ds_write_addtid_b32 v86 offset:44096
    ds_write_addtid_b32 v93 offset:46544
    ds_write_addtid_b32 v94 offset:46272
    ds_write_addtid_b32 v95 offset:47360
    v_pk_fma_f32 v[212:213], v[210:211], v[210:211], v[212:213] op_sel:[1,1,0] op_sel_hi:[0,1,1] neg_lo:[1,0,0]
    ds_write_addtid_b32 v8 offset:47904
    ds_read_b128 v[144:147], v20 offset:0
    ds_read_b128 v[160:163], v21 offset:0
    ds_read_b128 v[148:151], v20 offset:16
    ds_read_b128 v[164:167], v21 offset:16
    ds_read_b128 v[152:155], v20 offset:32
    ds_read_b128 v[168:171], v21 offset:32
    ds_read_b128 v[156:159], v20 offset:48
    s_waitcnt lgkmcnt(15)
    v_pk_mul_f16 v96, v112, v128 op_sel:[0,0] op_sel_hi:[1,0]
    v_cvt_pk_f16_f32 v67, v198, v199
    v_pk_mul_f16 v97, v113, v129 op_sel:[0,0] op_sel_hi:[1,0]
    v_cvt_pk_f16_f32 v68, v200, v201
    v_pk_fma_f16 v96, v112, v128, v96 op_sel:[1,1,0] op_sel_hi:[0,1,1] neg_lo:[1,0,0]
    v_cvt_pk_f16_f32 v70, v204, v205
    v_pk_fma_f16 v97, v113, v129, v97 op_sel:[1,1,0] op_sel_hi:[0,1,1] neg_lo:[1,0,0]
    v_cvt_pk_f16_f32 v71, v206, v207
    v_pk_mul_f16 v98, v114, v130 op_sel:[0,0] op_sel_hi:[1,0]
    v_pk_mul_f16 v69, v67, v68 op_sel:[0,0] op_sel_hi:[1,0]
    v_pk_mul_f16 v99, v115, v131 op_sel:[0,0] op_sel_hi:[1,0]
    v_pk_mul_f16 v72, v70, v71 op_sel:[0,0] op_sel_hi:[1,0]
    v_pk_fma_f16 v98, v114, v130, v98 op_sel:[1,1,0] op_sel_hi:[0,1,1] neg_lo:[1,0,0]
    v_pk_fma_f16 v69, v67, v68, v69 op_sel:[1,1,0] op_sel_hi:[0,1,1] neg_lo:[1,0,0]
    v_pk_fma_f16 v99, v115, v131, v99 op_sel:[1,1,0] op_sel_hi:[0,1,1] neg_lo:[1,0,0]
    v_pk_fma_f16 v72, v70, v71, v72 op_sel:[1,1,0] op_sel_hi:[0,1,1] neg_lo:[1,0,0]
    v_pk_mul_f16 v100, v116, v132 op_sel:[0,0] op_sel_hi:[1,0]
    v_pk_mul_f16 v74, v67, v70 op_sel:[0,0] op_sel_hi:[1,0]
    v_pk_mul_f16 v101, v117, v133 op_sel:[0,0] op_sel_hi:[1,0]
    v_pk_fma_f16 v100, v116, v132, v100 op_sel:[1,1,0] op_sel_hi:[0,1,1] neg_lo:[1,0,0]
    v_pk_mul_f16 v75, v68, v70 op_sel:[0,0] op_sel_hi:[1,0]
    v_pk_fma_f16 v101, v117, v133, v101 op_sel:[1,1,0] op_sel_hi:[0,1,1] neg_lo:[1,0,0]
    v_pk_mul_f16 v76, v69, v70 op_sel:[0,0] op_sel_hi:[1,0]
    v_pk_mul_f16 v102, v118, v134 op_sel:[0,0] op_sel_hi:[1,0]
    v_pk_mul_f16 v77, v67, v71 op_sel:[0,0] op_sel_hi:[1,0]
    v_pk_mul_f16 v103, v119, v135 op_sel:[0,0] op_sel_hi:[1,0]
    v_pk_mul_f16 v78, v68, v71 op_sel:[0,0] op_sel_hi:[1,0]
    v_pk_fma_f16 v102, v118, v134, v102 op_sel:[1,1,0] op_sel_hi:[0,1,1] neg_lo:[1,0,0]
    v_pk_mul_f16 v79, v69, v71 op_sel:[0,0] op_sel_hi:[1,0]
    v_pk_fma_f16 v103, v119, v135, v103 op_sel:[1,1,0] op_sel_hi:[0,1,1] neg_lo:[1,0,0]
    v_pk_mul_f16 v80, v67, v72 op_sel:[0,0] op_sel_hi:[1,0]
    v_pk_mul_f16 v104, v120, v136 op_sel:[0,0] op_sel_hi:[1,0]
    v_pk_mul_f16 v6, v68, v72 op_sel:[0,0] op_sel_hi:[1,0]
    s_waitcnt lgkmcnt(6)
    v_mfma_f32_16x16x32_f16 v[176:179], v[144:147], v[112:115], 0
    v_pk_mul_f16 v7, v69, v72 op_sel:[0,0] op_sel_hi:[1,0]
    v_pk_mul_f16 v105, v121, v137 op_sel:[0,0] op_sel_hi:[1,0]
    v_pk_fma_f16 v104, v120, v136, v104 op_sel:[1,1,0] op_sel_hi:[0,1,1] neg_lo:[1,0,0]
    v_cvt_pk_f16_f32 v73, v210, v211
    s_waitcnt lgkmcnt(5)
    v_mfma_f32_16x16x32_f16 v[184:187], v[160:163], v[112:115], 0
    v_pk_fma_f16 v74, v67, v70, v74 op_sel:[1,1,0] op_sel_hi:[0,1,1] neg_lo:[1,0,0]
    v_pk_fma_f16 v105, v121, v137, v105 op_sel:[1,1,0] op_sel_hi:[0,1,1] neg_lo:[1,0,0]
    v_pk_fma_f16 v75, v68, v70, v75 op_sel:[1,1,0] op_sel_hi:[0,1,1] neg_lo:[1,0,0]
    v_pk_mul_f16 v106, v122, v138 op_sel:[0,0] op_sel_hi:[1,0]
    v_pk_fma_f16 v76, v69, v70, v76 op_sel:[1,1,0] op_sel_hi:[0,1,1] neg_lo:[1,0,0]
    s_waitcnt lgkmcnt(4)
    v_mfma_f32_16x16x32_f16 v[176:179], v[148:151], v[116:119], v[176:179]
    v_pk_fma_f16 v77, v67, v71, v77 op_sel:[1,1,0] op_sel_hi:[0,1,1] neg_lo:[1,0,0]
    v_pk_mul_f16 v107, v123, v139 op_sel:[0,0] op_sel_hi:[1,0]
    v_pk_fma_f16 v78, v68, v71, v78 op_sel:[1,1,0] op_sel_hi:[0,1,1] neg_lo:[1,0,0]
    v_pk_fma_f16 v106, v122, v138, v106 op_sel:[1,1,0] op_sel_hi:[0,1,1] neg_lo:[1,0,0]
    v_pk_fma_f16 v79, v69, v71, v79 op_sel:[1,1,0] op_sel_hi:[0,1,1] neg_lo:[1,0,0]
    s_waitcnt lgkmcnt(3)
    v_mfma_f32_16x16x32_f16 v[184:187], v[164:167], v[116:119], v[184:187]
    v_pk_fma_f16 v80, v67, v72, v80 op_sel:[1,1,0] op_sel_hi:[0,1,1] neg_lo:[1,0,0]
    v_pk_fma_f16 v107, v123, v139, v107 op_sel:[1,1,0] op_sel_hi:[0,1,1] neg_lo:[1,0,0]
    v_pk_fma_f16 v6, v68, v72, v6 op_sel:[1,1,0] op_sel_hi:[0,1,1] neg_lo:[1,0,0]
    v_pk_mul_f16 v108, v124, v140 op_sel:[0,0] op_sel_hi:[1,0]
    s_cmp_eq_u32 s30, 0
    s_cbranch_scc0 L_nu2
    buffer_load_dwordx2 v[238:239], v28, s[20:23], s54 offen
L_nu2:
    s_waitcnt lgkmcnt(2)
    v_mfma_f32_16x16x32_f16 v[176:179], v[152:155], v[120:123], v[176:179]
    v_pk_fma_f16 v7, v69, v72, v7 op_sel:[1,1,0] op_sel_hi:[0,1,1] neg_lo:[1,0,0]
    v_pk_mul_f16 v109, v125, v141 op_sel:[0,0] op_sel_hi:[1,0]
    v_pk_fma_f16 v108, v124, v140, v108 op_sel:[1,1,0] op_sel_hi:[0,1,1] neg_lo:[1,0,0]
    s_waitcnt lgkmcnt(1)
    v_mfma_f32_16x16x32_f16 v[184:187], v[168:171], v[120:123], v[184:187]
    ds_read_b128 v[172:175], v21 offset:48
    ds_write_addtid_b32 v67 offset:1360
    ds_write_addtid_b32 v68 offset:1632
    ds_write_addtid_b32 v69 offset:1904
    v_pk_fma_f16 v109, v125, v141, v109 op_sel:[1,1,0] op_sel_hi:[0,1,1] neg_lo:[1,0,0]
    v_pk_mul_f16 v110, v126, v142 op_sel:[0,0] op_sel_hi:[1,0]
    s_waitcnt lgkmcnt(4)
    v_mfma_f32_16x16x32_f16 v[176:179], v[156:159], v[124:127], v[176:179]
    v_pk_mul_f16 v111, v127, v143 op_sel:[0,0] op_sel_hi:[1,0]
    ds_write_addtid_b32 v70 offset:0
    ds_write_addtid_b32 v71 offset:2176
    ds_write_addtid_b32 v72 offset:3264
    ds_write_addtid_b32 v73 offset:43280
    v_pk_fma_f16 v110, v126, v142, v110 op_sel:[1,1,0] op_sel_hi:[0,1,1] neg_lo:[1,0,0]
    s_waitcnt lgkmcnt(7)
    v_mfma_f32_16x16x32_f16 v[184:187], v[172:175], v[124:127], v[184:187]
    s_setprio 0
    v_pk_fma_f16 v111, v127, v143, v111 op_sel:[1,1,0] op_sel_hi:[0,1,1] neg_lo:[1,0,0]
    v_mfma_f32_16x16x32_f16 v[180:183], v[144:147], v[96:99], 0
    v_mfma_f32_16x16x32_f16 v[188:191], v[160:163], v[96:99], 0
    ds_write_addtid_b32 v74 offset:272
    ds_write_addtid_b32 v75 offset:544
    ds_write_addtid_b32 v76 offset:816
    ds_write_addtid_b32 v77 offset:2448
    v_mfma_f32_16x16x32_f16 v[180:183], v[148:151], v[100:103], v[180:183]
    v_mfma_f32_16x16x32_f16 v[188:191], v[164:167], v[100:103], v[188:191]
    v_mfma_f32_16x16x32_f16 v[180:183], v[152:155], v[104:107], v[180:183]
    v_mfma_f32_16x16x32_f16 v[188:191], v[168:171], v[104:107], v[188:191]
    ds_write_addtid_b32 v78 offset:2720
    ds_write_addtid_b32 v79 offset:2992
    ds_write_addtid_b32 v80 offset:3536
    ds_write_addtid_b32 v6 offset:3808
    v_mfma_f32_16x16x32_f16 v[180:183], v[156:159], v[108:111], v[180:183]
    v_mfma_f32_16x16x32_f16 v[188:191], v[172:175], v[108:111], v[188:191]
    ds_write_addtid_b32 v7 offset:4080
    ds_read_b128 v[112:115], v22 offset:0
    ds_read_b128 v[128:131], v23 offset:0
    ds_read_b128 v[116:119], v22 offset:16
    ds_read_b128 v[132:135], v23 offset:16
    ds_read_b128 v[120:123], v22 offset:32
    ds_read_b128 v[136:139], v23 offset:32
    ds_read_b128 v[124:127], v22 offset:48
    v_pk_mul_f32 v[216:217], v[214:215], v[212:213] op_sel:[0,0] op_sel_hi:[1,0]
    v_cvt_pk_f16_f32 v242, v214, v215
    v_pk_fma_f32 v[216:217], v[214:215], v[212:213], v[216:217] op_sel:[1,1,0] op_sel_hi:[0,1,1] neg_hi:[1,0,0]
    v_pk_mul_f16 v82, v242, v222 op_sel:[0,0] op_sel_hi:[1,0]
    v_pk_mul_f32 v[214:215], v[216:217], v[212:213] op_sel:[0,0] op_sel_hi:[1,0]
    v_cvt_pk_f16_f32 v243, v216, v217
    v_pk_fma_f32 v[214:215], v[216:217], v[212:213], v[214:215] op_sel:[1,1,0] op_sel_hi:[0,1,1] neg_hi:[1,0,0]
    v_pk_fma_f16 v82, v242, v222, v82 op_sel:[1,1,0] op_sel_hi:[0,1,1] neg_hi:[1,0,0]
    v_pk_mul_f32 v[216:217], v[214:215], v[212:213] op_sel:[0,0] op_sel_hi:[1,0]
    v_cvt_pk_f16_f32 v244, v214, v215
    v_pk_fma_f32 v[216:217], v[214:215], v[212:213], v[216:217] op_sel:[1,1,0] op_sel_hi:[0,1,1] neg_hi:[1,0,0]
    v_pk_mul_f16 v83, v242, v223 op_sel:[0,0] op_sel_hi:[1,0]
    v_pk_mul_f32 v[214:215], v[216:217], v[212:213] op_sel:[0,0] op_sel_hi:[1,0]
    v_cvt_pk_f16_f32 v245, v216, v217
    v_pk_fma_f32 v[214:215], v[216:217], v[212:213], v[214:215] op_sel:[1,1,0] op_sel_hi:[0,1,1] neg_hi:[1,0,0]
    v_pk_mul_f16 v84, v82, v223 op_sel:[0,0] op_sel_hi:[1,0]
    v_pk_mul_f32 v[216:217], v[214:215], v[212:213] op_sel:[0,0] op_sel_hi:[1,0]
    v_cvt_pk_f16_f32 v246, v214, v215
    v_pk_fma_f32 v[216:217], v[214:215], v[212:213], v[216:217] op_sel:[1,1,0] op_sel_hi:[0,1,1] neg_hi:[1,0,0]
    v_pk_mul_f16 v86, v243, v223 op_sel:[0,0] op_sel_hi:[1,0]
    v_pk_mul_f32 v[214:215], v[216:217], v[212:213] op_sel:[0,0] op_sel_hi:[1,0]
    v_cvt_pk_f16_f32 v247, v216, v217
    v_pk_fma_f32 v[214:215], v[216:217], v[212:213], v[214:215] op_sel:[1,1,0] op_sel_hi:[0,1,1] neg_hi:[1,0,0]
    v_pk_fma_f16 v83, v242, v223, v83 op_sel:[1,1,0] op_sel_hi:[0,1,1] neg_hi:[1,0,0]
    v_pk_mul_f32 v[216:217], v[214:215], v[212:213] op_sel:[0,0] op_sel_hi:[1,0]
    s_cmp_eq_u32 s30, 0
    s_cbranch_scc0 L_nu3
    buffer_load_dwordx2 v[240:241], v28, s[20:23], s54 offen offset:896
L_nu3:
    v_cvt_pk_f16_f32 v248, v214, v215
    v_pk_fma_f32 v[216:217], v[214:215], v[212:213], v[216:217] op_sel:[1,1,0] op_sel_hi:[0,1,1] neg_hi:[1,0,0]
    v_pk_fma_f16 v84, v82, v223, v84 op_sel:[1,1,0] op_sel_hi:[0,1,1] neg_hi:[1,0,0]
    v_pk_mul_f32 v[214:215], v[216:217], v[212:213] op_sel:[0,0] op_sel_hi:[1,0]
    v_pk_fma_f16 v86, v243, v223, v86 op_sel:[1,1,0] op_sel_hi:[0,1,1] neg_hi:[1,0,0]
    v_pk_mul_f16 v89, v242, v224 op_sel:[0,0] op_sel_hi:[1,0]
    v_pk_mul_f16 v90, v82, v224 op_sel:[0,0] op_sel_hi:[1,0]
    v_pk_mul_f16 v91, v83, v224 op_sel:[0,0] op_sel_hi:[1,0]
    v_pk_mul_f16 v92, v84, v224 op_sel:[0,0] op_sel_hi:[1,0]
    v_pk_fma_f32 v[214:215], v[216:217], v[212:213], v[214:215] op_sel:[1,1,0] op_sel_hi:[0,1,1] neg_hi:[1,0,0]
    v_pk_mul_f16 v93, v243, v224 op_sel:[0,0] op_sel_hi:[1,0]
    v_pk_mul_f16 v94, v86, v224 op_sel:[0,0] op_sel_hi:[1,0]
    v_pk_mul_f16 v95, v244, v224 op_sel:[0,0] op_sel_hi:[1,0]
    v_pk_mul_f16 v8, v245, v224 op_sel:[0,0] op_sel_hi:[1,0]
    v_pk_fma_f16 v89, v242, v224, v89 op_sel:[1,1,0] op_sel_hi:[0,1,1] neg_hi:[1,0,0]
    v_pk_fma_f16 v90, v82, v224, v90 op_sel:[1,1,0] op_sel_hi:[0,1,1] neg_hi:[1,0,0]
    v_pk_fma_f16 v91, v83, v224, v91 op_sel:[1,1,0] op_sel_hi:[0,1,1] neg_hi:[1,0,0]
    v_pk_fma_f16 v92, v84, v224, v92 op_sel:[1,1,0] op_sel_hi:[0,1,1] neg_hi:[1,0,0]
    v_cvt_pk_f16_f32 v249, v216, v217
    v_cvt_pk_f16_f32 v250, v214, v215
    v_pk_fma_f16 v93, v243, v224, v93 op_sel:[1,1,0] op_sel_hi:[0,1,1] neg_hi:[1,0,0]
    v_pk_fma_f16 v94, v86, v224, v94 op_sel:[1,1,0] op_sel_hi:[0,1,1] neg_hi:[1,0,0]
    v_pk_fma_f16 v95, v244, v224, v95 op_sel:[1,1,0] op_sel_hi:[0,1,1] neg_hi:[1,0,0]
    v_pk_fma_f16 v8, v245, v224, v8 op_sel:[1,1,0] op_sel_hi:[0,1,1] neg_hi:[1,0,0]
    ds_read_b128 v[140:143], v23 offset:48
    ds_write_addtid_b32 v242 offset:43824
    ds_write_addtid_b32 v82 offset:45728
    ds_write_addtid_b32 v83 offset:45184
    ds_write_addtid_b32 v89 offset:4624
    ds_write_addtid_b32 v84 offset:46816
    ds_write_addtid_b32 v90 offset:43552
    ds_write_addtid_b32 v91 offset:4352
    ds_write_addtid_b32 v92 offset:44640
    ds_write_addtid_b32 v243 offset:47088
    ds_write_addtid_b32 v244 offset:44368
    ds_write_addtid_b32 v245 offset:47632
    ds_write_addtid_b32 v246 offset:45456
    ds_write_addtid_b32 v247 offset:46000
    ds_write_addtid_b32 v248 offset:43008
    ds_write_addtid_b32 v249 offset:4896
    ds_write_addtid_b32 v250 offset:44912
    ds_write_addtid_b32 v86 offset:44096
    ds_write_addtid_b32 v93 offset:46544
    ds_write_addtid_b32 v94 offset:46272
    ds_write_addtid_b32 v95 offset:47360
    ds_write_addtid_b32 v8 offset:47904
    ds_read_b128 v[144:147], v20 offset:0
    ds_read_b128 v[160:163], v21 offset:0
    ds_read_b128 v[148:151], v20 offset:16
    ds_read_b128 v[164:167], v21 offset:16
    ds_read_b128 v[152:155], v20 offset:32
    ds_read_b128 v[168:171], v21 offset:32
    ds_read_b128 v[156:159], v20 offset:48
    ds_read_b128 v[172:175], v21 offset:48
    s_waitcnt lgkmcnt(15)
    v_pk_mul_f16 v96, v112, v128 op_sel:[0,0] op_sel_hi:[1,0]
    v_pk_mul_f16 v97, v113, v129 op_sel:[0,0] op_sel_hi:[1,0]
    v_pk_fma_f16 v96, v112, v128, v96 op_sel:[1,1,0] op_sel_hi:[0,1,1] neg_lo:[1,0,0]
    v_pk_fma_f16 v97, v113, v129, v97 op_sel:[1,1,0] op_sel_hi:[0,1,1] neg_lo:[1,0,0]
    v_pk_mul_f16 v98, v114, v130 op_sel:[0,0] op_sel_hi:[1,0]
    v_pk_mul_f16 v99, v115, v131 op_sel:[0,0] op_sel_hi:[1,0]
    v_pk_fma_f16 v98, v114, v130, v98 op_sel:[1,1,0] op_sel_hi:[0,1,1] neg_lo:[1,0,0]
    v_pk_fma_f16 v99, v115, v131, v99 op_sel:[1,1,0] op_sel_hi:[0,1,1] neg_lo:[1,0,0]
    v_pk_mul_f16 v100, v116, v132 op_sel:[0,0] op_sel_hi:[1,0]
    v_pk_mul_f16 v101, v117, v133 op_sel:[0,0] op_sel_hi:[1,0]
    v_pk_fma_f16 v100, v116, v132, v100 op_sel:[1,1,0] op_sel_hi:[0,1,1] neg_lo:[1,0,0]
    v_pk_fma_f16 v101, v117, v133, v101 op_sel:[1,1,0] op_sel_hi:[0,1,1] neg_lo:[1,0,0]
    v_pk_mul_f16 v102, v118, v134 op_sel:[0,0] op_sel_hi:[1,0]
    v_pk_mul_f16 v103, v119, v135 op_sel:[0,0] op_sel_hi:[1,0]
    v_pk_fma_f16 v102, v118, v134, v102 op_sel:[1,1,0] op_sel_hi:[0,1,1] neg_lo:[1,0,0]
    v_pk_fma_f16 v103, v119, v135, v103 op_sel:[1,1,0] op_sel_hi:[0,1,1] neg_lo:[1,0,0]
    s_cmp_eq_u32 s30, 0
    s_cbranch_scc1 L_F
    s_setprio 3
    s_waitcnt vmcnt(0)
    v_add_u32 v3, s43, v3
    v_add_u32 v24, s41, v24
    v_add_u32 v25, s41, v25
    v_add_u32 v26, s34, v26
    v_pk_mul_f16 v104, v120, v136 op_sel:[0,0] op_sel_hi:[1,0]
    s_waitcnt lgkmcnt(7)
    v_mfma_f32_16x16x32_f16 v[176:179], v[144:147], v[112:115], v[176:179]
    v_pk_mul_f16 v105, v121, v137 op_sel:[0,0] op_sel_hi:[1,0]
    v_pk_fma_f16 v104, v120, v136, v104 op_sel:[1,1,0] op_sel_hi:[0,1,1] neg_lo:[1,0,0]
    s_waitcnt lgkmcnt(6)
    v_mfma_f32_16x16x32_f16 v[184:187], v[160:163], v[112:115], v[184:187]
    v_pk_fma_f16 v105, v121, v137, v105 op_sel:[1,1,0] op_sel_hi:[0,1,1] neg_lo:[1,0,0]
    v_pk_mul_f16 v106, v122, v138 op_sel:[0,0] op_sel_hi:[1,0]
    s_waitcnt lgkmcnt(5)
    v_mfma_f32_16x16x32_f16 v[176:179], v[148:151], v[116:119], v[176:179]
    v_pk_mul_f16 v107, v123, v139 op_sel:[0,0] op_sel_hi:[1,0]
    v_pk_fma_f16 v106, v122, v138, v106 op_sel:[1,1,0] op_sel_hi:[0,1,1] neg_lo:[1,0,0]
    s_waitcnt lgkmcnt(4)
    v_mfma_f32_16x16x32_f16 v[184:187], v[164:167], v[116:119], v[184:187]
    v_pk_fma_f16 v107, v123, v139, v107 op_sel:[1,1,0] op_sel_hi:[0,1,1] neg_lo:[1,0,0]
    v_pk_mul_f16 v108, v124, v140 op_sel:[0,0] op_sel_hi:[1,0]
    s_waitcnt lgkmcnt(3)
    v_mfma_f32_16x16x32_f16 v[176:179], v[152:155], v[120:123], v[176:179]
    v_pk_mul_f16 v109, v125, v141 op_sel:[0,0] op_sel_hi:[1,0]
    v_pk_fma_f16 v108, v124, v140, v108 op_sel:[1,1,0] op_sel_hi:[0,1,1] neg_lo:[1,0,0]
    s_waitcnt lgkmcnt(2)
    v_mfma_f32_16x16x32_f16 v[184:187], v[168:171], v[120:123], v[184:187]
    v_pk_fma_f16 v109, v125, v141, v109 op_sel:[1,1,0] op_sel_hi:[0,1,1] neg_lo:[1,0,0]
    v_pk_mul_f16 v110, v126, v142 op_sel:[0,0] op_sel_hi:[1,0]
    s_waitcnt lgkmcnt(1)
    v_mfma_f32_16x16x32_f16 v[176:179], v[156:159], v[124:127], v[176:179]
    v_pk_mul_f16 v111, v127, v143 op_sel:[0,0] op_sel_hi:[1,0]
    v_pk_fma_f16 v110, v126, v142, v110 op_sel:[1,1,0] op_sel_hi:[0,1,1] neg_lo:[1,0,0]
    s_waitcnt lgkmcnt(0)
    v_mfma_f32_16x16x32_f16 v[184:187], v[172:175], v[124:127], v[184:187]
    v_pk_fma_f16 v111, v127, v143, v111 op_sel:[1,1,0] op_sel_hi:[0,1,1] neg_lo:[1,0,0]
    s_cmp_eq_u32 s31, 0
    s_cbranch_scc0 L_M1
    s_barrier
    v_mfma_f32_16x16x32_f16 v[180:183], v[144:147], v[96:99], v[180:183]
    v_mfma_f32_16x16x32_f16 v[188:191], v[160:163], v[96:99], v[188:191]
    ds_read_b128 v[192:195], v3 offset:43008
    ds_read_b128 v[196:199], v3 offset:44032
    ds_read_b128 v[200:203], v3 offset:45056
    ds_read_b128 v[204:207], v3 offset:46080
    ds_read_b64_tr_b16 v[224:225], v26 offset:1824
    v_mfma_f32_16x16x32_f16 v[180:183], v[148:151], v[100:103], v[180:183]
    v_mfma_f32_16x16x32_f16 v[188:191], v[164:167], v[100:103], v[188:191]
    ds_read_b64_tr_b16 v[226:227], v26 offset:1792
    ds_read_b64_tr_b16 v[228:229], v26 offset:1568
    ds_read_b64_tr_b16 v[230:231], v26 offset:1536
    ds_read_b64_tr_b16 v[232:233], v26 offset:1312
    ds_read_b64_tr_b16 v[234:235], v26 offset:1280
    v_mfma_f32_16x16x32_f16 v[180:183], v[152:155], v[104:107], v[180:183]
    v_mfma_f32_16x16x32_f16 v[188:191], v[168:171], v[104:107], v[188:191]
    ds_read_b64_tr_b16 v[236:237], v26 offset:1056
    ds_read_b64_tr_b16 v[238:239], v26 offset:1024
    ds_read_b64_tr_b16 v[240:241], v26 offset:800
    ds_read_b64_tr_b16 v[242:243], v26 offset:768
    ds_read_b64_tr_b16 v[244:245], v26 offset:544
    v_mfma_f32_16x16x32_f16 v[180:183], v[156:159], v[108:111], v[180:183]
    v_mfma_f32_16x16x32_f16 v[188:191], v[172:175], v[108:111], v[188:191]
    ds_read_b64_tr_b16 v[246:247], v26 offset:512
    ds_read_b64_tr_b16 v[248:249], v26 offset:288
    ds_read_b64_tr_b16 v[250:251], v26 offset:256
    ds_read_b64_tr_b16 v[252:253], v26 offset:32
    ds_read_b64_tr_b16 v[254:255], v26 offset:0
    s_waitcnt lgkmcnt(15)
    v_fma_f32 v176, v176, v18, v192
    v_fma_f32 v177, v177, v18, v193
    v_fma_f32 v180, v180, v18, v196
    v_fma_f32 v181, v181, v18, v197
    v_cvt_pk_bf16_f32 v223, v176, v177
    v_cvt_pk_bf16_f32 v17, v180, v181
    v_fma_f32 v179, v179, v18, v195
    v_fma_f32 v183, v183, v18, v199
    v_permlane16_swap_b32 v223, v17
    ds_write_b32 v25, v223 offset:128
    ds_write_b32 v25, v17 offset:1312
    v_fma_f32 v178, v178, v18, v194
    v_fma_f32 v182, v182, v18, v198
    v_permlane16_swap_b32 v179, v183
    v_fma_f32 v184, v184, v18, v200
    v_permlane16_swap_b32 v178, v182
    v_mov_b32 v210, v183
    v_fma_f32 v188, v188, v18, v204
    v_cvt_pk_bf16_f32 v208, v178, v179
    v_mov_b32_dpp v210, v184 wave_rol:1 row_mask:0x8 bank_mask:0xf
    v_fma_f32 v185, v185, v18, v201
    ds_write_b32 v25, v208 offset:256
    v_mov_b32_dpp v210, v183 wave_shl:1 row_mask:0xc bank_mask:0xf
    v_fma_f32 v189, v189, v18, v205
    v_cvt_pk_bf16_f32 v209, v182, v210
    ds_write_b32 v25, v209 offset:1440
    ds_read2_b64 v[64:67], v24 offset0:28 offset1:29
    v_permlane16_swap_b32 v184, v188
    v_permlane16_swap_b32 v185, v189
    v_fma_f32 v186, v186, v18, v202
    v_mov_b32_dpp v211, v188 wave_rol:1 row_mask:0xf bank_mask:0xf
    v_cvt_pk_bf16_f32 v212, v184, v185
    s_nop 0
    v_mov_b32_dpp v211, v184 wave_shl:1 row_mask:0xf bank_mask:0xf
    s_mov_b32 m0, s3
    s_nop 0
    ds_write_addtid_b32 v212 offset:45440
    ds_write_addtid_b32 v212 offset:46624
    v_cvt_pk_bf16_f32 v213, v184, v211
    v_cvt_pk_bf16_f32 v214, v185, v211
    ds_write_addtid_b32 v213 offset:47808
    ds_write_addtid_b32 v214 offset:48992
    ds_read2_b64 v[68:71], v24 offset0:32 offset1:33
    ds_read2_b64 v[72:75], v24 offset0:36 offset1:37
    s_waitcnt lgkmcnt(6)
    v_mfma_f32_16x16x32_bf16 v[28:31], v[64:67], v[224:227], 0
    ds_read2_b64 v[76:79], v24 offset0:40 offset1:41
    ds_read2_b64 v[80:83], v24 offset0:44 offset1:45
    s_waitcnt lgkmcnt(3)
    v_mfma_f32_16x16x32_bf16 v[32:35], v[68:71], v[224:227], 0
    v_mov_b32_dpp v215, v189 wave_rol:1 row_mask:0xf bank_mask:0xf
    s_waitcnt lgkmcnt(2)
    v_mfma_f32_16x16x32_bf16 v[36:39], v[72:75], v[224:227], 0
    ds_read2_b64 v[84:87], v24 offset0:48 offset1:49
    s_waitcnt lgkmcnt(2)
    v_mfma_f32_16x16x32_bf16 v[40:43], v[76:79], v[224:227], 0
    ds_read2_b64 v[88:91], v24 offset0:52 offset1:53
    s_waitcnt lgkmcnt(2)
    v_mfma_f32_16x16x32_bf16 v[44:47], v[80:83], v[224:227], 0
    v_mfma_f32_16x16x32_bf16 v[28:31], v[72:75], v[228:231], v[28:31]
    v_mov_b32_dpp v215, v188 wave_shl:1 row_mask:0xf bank_mask:0xf
    v_cvt_pk_bf16_f32 v217, v188, v215
    v_bfi_b32 v216, v27, v215, v188
    v_mfma_f32_16x16x32_bf16 v[32:35], v[76:79], v[228:231], v[32:35]
    ds_write_addtid_b32 v217 offset:46880
    v_mfma_f32_16x16x32_bf16 v[36:39], v[80:83], v[228:231], v[36:39]
    ds_read2_b64 v[92:95], v24 offset0:56 offset1:57
    s_waitcnt lgkmcnt(3)
    v_mfma_f32_16x16x32_bf16 v[40:43], v[84:87], v[228:231], v[40:43]
    ds_read2_b64 v[96:99], v24 offset0:60 offset1:61
    s_waitcnt lgkmcnt(3)
    v_mfma_f32_16x16x32_bf16 v[44:47], v[88:91], v[228:231], v[44:47]
    v_cvt_pk_bf16_f32 v218, v188, v216
    v_mfma_f32_16x16x32_bf16 v[28:31], v[80:83], v[232:235], v[28:31]
    ds_write_addtid_b32 v217 offset:48064
    v_mfma_f32_16x16x32_bf16 v[32:35], v[84:87], v[232:235], v[32:35]
    ds_write_addtid_b32 v217 offset:49248
    v_mfma_f32_16x16x32_bf16 v[36:39], v[88:91], v[232:235], v[36:39]
    ds_write_addtid_b32 v218 offset:45696
    ds_read2_b64 v[100:103], v24 offset0:64 offset1:65
    s_waitcnt lgkmcnt(5)
    v_mfma_f32_16x16x32_bf16 v[40:43], v[92:95], v[232:235], v[40:43]
    ds_read2_b64 v[104:107], v24 offset0:68 offset1:69
    s_waitcnt lgkmcnt(5)
    v_mfma_f32_16x16x32_bf16 v[44:47], v[96:99], v[232:235], v[44:47]
    v_mfma_f32_16x16x32_bf16 v[28:31], v[88:91], v[236:239], v[28:31]
    v_mov_b32_dpp v219, v186 wave_rol:1 row_mask:0xf bank_mask:0xf
    s_nop 1
    v_mov_b32_dpp v219, v189 wave_shl:1 row_mask:0xf bank_mask:0xf
    v_mfma_f32_16x16x32_bf16 v[32:35], v[92:95], v[236:239], v[32:35]
    v_cvt_pk_bf16_f32 v221, v189, v219
    v_bfi_b32 v220, v27, v219, v189
    v_mfma_f32_16x16x32_bf16 v[36:39], v[96:99], v[236:239], v[36:39]
    ds_read2_b64 v[108:111], v24 offset0:72 offset1:73
    s_waitcnt lgkmcnt(2)
    v_mfma_f32_16x16x32_bf16 v[40:43], v[100:103], v[236:239], v[40:43]
    ds_read2_b64 v[112:115], v24 offset0:76 offset1:77
    s_waitcnt lgkmcnt(2)
    v_mfma_f32_16x16x32_bf16 v[44:47], v[104:107], v[236:239], v[44:47]
    ds_write_addtid_b32 v221 offset:47136
    v_mfma_f32_16x16x32_bf16 v[28:31], v[96:99], v[240:243], v[28:31]
    v_cvt_pk_bf16_f32 v222, v189, v220
    v_mfma_f32_16x16x32_bf16 v[32:35], v[100:103], v[240:243], v[32:35]
    ds_write_addtid_b32 v221 offset:48320
    v_mfma_f32_16x16x32_bf16 v[36:39], v[104:107], v[240:243], v[36:39]
    ds_read2_b64 v[116:119], v24 offset0:80 offset1:81
    s_waitcnt lgkmcnt(4)
    v_mfma_f32_16x16x32_bf16 v[40:43], v[108:111], v[240:243], v[40:43]
    ds_read2_b64 v[120:123], v24 offset0:84 offset1:85
    s_waitcnt lgkmcnt(4)
    v_mfma_f32_16x16x32_bf16 v[44:47], v[112:115], v[240:243], v[44:47]
    s_barrier
    v_mfma_f32_16x16x32_bf16 v[28:31], v[104:107], v[244:247], v[28:31]
    ds_write_addtid_b32 v221 offset:49504
    v_mfma_f32_16x16x32_bf16 v[32:35], v[108:111], v[244:247], v[32:35]
    ds_write_addtid_b32 v222 offset:45952
    v_mfma_f32_16x16x32_bf16 v[36:39], v[112:115], v[244:247], v[36:39]
    ds_read2_b64 v[124:127], v24 offset0:88 offset1:89
    s_waitcnt lgkmcnt(4)
    v_mfma_f32_16x16x32_bf16 v[40:43], v[116:119], v[244:247], v[40:43]
    ds_read2_b64 v[128:131], v24 offset0:92 offset1:93
    s_waitcnt lgkmcnt(4)
    v_mfma_f32_16x16x32_bf16 v[44:47], v[120:123], v[244:247], v[44:47]
    ds_read2_b64 v[132:135], v24 offset0:96 offset1:97
    v_mfma_f32_16x16x32_bf16 v[28:31], v[112:115], v[248:251], v[28:31]
    ds_read2_b64 v[136:139], v24 offset0:100 offset1:101
    v_mfma_f32_16x16x32_bf16 v[32:35], v[116:119], v[248:251], v[32:35]
    ds_read_b64_tr_b16 v[140:141], v26 offset:2080
    ds_read_b64_tr_b16 v[142:143], v26 offset:2048
    v_mfma_f32_16x16x32_bf16 v[36:39], v[120:123], v[248:251], v[36:39]
    s_waitcnt lgkmcnt(5)
    v_mfma_f32_16x16x32_bf16 v[40:43], v[124:127], v[248:251], v[40:43]
    ds_read2_b64 v[144:147], v24 offset0:20 offset1:21
    s_waitcnt lgkmcnt(5)
    v_mfma_f32_16x16x32_bf16 v[44:47], v[128:131], v[248:251], v[44:47]
    ds_read2_b64 v[148:151], v24 offset0:24 offset1:25
    v_mfma_f32_16x16x32_bf16 v[28:31], v[120:123], v[252:255], v[28:31]
    ds_read_b64_tr_b16 v[152:153], v26 offset:2336
    ds_read_b64_tr_b16 v[154:155], v26 offset:2304
    v_mfma_f32_16x16x32_bf16 v[32:35], v[124:127], v[252:255], v[32:35]
    v_mfma_f32_16x16x32_bf16 v[36:39], v[128:131], v[252:255], v[36:39]
    ds_read2_b64 v[156:159], v24 offset0:12 offset1:13
    s_waitcnt lgkmcnt(8)
    v_mfma_f32_16x16x32_bf16 v[40:43], v[132:135], v[252:255], v[40:43]
    ds_read2_b64 v[160:163], v24 offset0:16 offset1:17
    s_waitcnt lgkmcnt(8)
    v_mfma_f32_16x16x32_bf16 v[44:47], v[136:139], v[252:255], v[44:47]
    ds_read_b64_tr_b16 v[164:165], v26 offset:2592
    ds_read_b64_tr_b16 v[166:167], v26 offset:2560
    s_waitcnt lgkmcnt(7)
    v_mfma_f32_16x16x32_bf16 v[28:31], v[144:147], v[140:143], v[28:31]
    s_barrier
    s_waitcnt lgkmcnt(6)
    v_mfma_f32_16x16x32_bf16 v[32:35], v[148:151], v[140:143], v[32:35]
    v_mfma_f32_16x16x32_bf16 v[36:39], v[64:67], v[140:143], v[36:39]
    ds_read2_b64 v[168:171], v24 offset0:4 offset1:5
    v_mfma_f32_16x16x32_bf16 v[40:43], v[68:71], v[140:143], v[40:43]
    ds_read2_b64 v[172:175], v24 offset0:8 offset1:9
    v_mfma_f32_16x16x32_bf16 v[44:47], v[72:75], v[140:143], v[44:47]
    ds_read_b64_tr_b16 v[176:177], v26 offset:2848
    ds_read_b64_tr_b16 v[178:179], v26 offset:2816
    s_waitcnt lgkmcnt(7)
    v_mfma_f32_16x16x32_bf16 v[28:31], v[156:159], v[152:155], v[28:31]
    ds_read2_b64 v[180:183], v24 offset0:0 offset1:1
    s_waitcnt lgkmcnt(7)
    v_mfma_f32_16x16x32_bf16 v[32:35], v[160:163], v[152:155], v[32:35]
    v_mfma_f32_16x16x32_bf16 v[36:39], v[144:147], v[152:155], v[36:39]
    ds_read_b64_tr_b16 v[184:185], v26 offset:3104
    ds_read_b64_tr_b16 v[186:187], v26 offset:3072
    v_mfma_f32_16x16x32_bf16 v[40:43], v[148:151], v[152:155], v[40:43]
    ds_read2_b64 v[188:191], v24 offset0:104 offset1:105
    v_mfma_f32_16x16x32_bf16 v[44:47], v[64:67], v[152:155], v[44:47]
    ds_read2_b64 v[192:195], v24 offset0:108 offset1:109
    s_waitcnt lgkmcnt(8)
    v_mfma_f32_16x16x32_bf16 v[28:31], v[168:171], v[164:167], v[28:31]
    ds_read_b64_tr_b16 v[196:197], v26 offset:3360
    ds_read_b64_tr_b16 v[198:199], v26 offset:3328
    s_waitcnt lgkmcnt(9)
    v_mfma_f32_16x16x32_bf16 v[32:35], v[172:175], v[164:167], v[32:35]
    v_mfma_f32_16x16x32_bf16 v[36:39], v[156:159], v[164:167], v[36:39]
    ds_read2_b64 v[200:203], v24 offset0:112 offset1:113
    v_mfma_f32_16x16x32_bf16 v[40:43], v[160:163], v[164:167], v[40:43]
    ds_read2_b64 v[204:207], v24 offset0:116 offset1:117
    v_mfma_f32_16x16x32_bf16 v[44:47], v[144:147], v[164:167], v[44:47]
    ds_read_b64_tr_b16 v[208:209], v26 offset:3616
    ds_read_b64_tr_b16 v[210:211], v26 offset:3584
    s_waitcnt lgkmcnt(10)
    v_mfma_f32_16x16x32_bf16 v[32:35], v[180:183], v[176:179], v[32:35]
    v_mfma_f32_16x16x32_bf16 v[36:39], v[168:171], v[176:179], v[36:39]
    ds_read2_b64 v[212:215], v24 offset0:120 offset1:121
    v_mfma_f32_16x16x32_bf16 v[40:43], v[172:175], v[176:179], v[40:43]
    ds_read2_b64 v[216:219], v24 offset0:124 offset1:125
    v_mfma_f32_16x16x32_bf16 v[44:47], v[156:159], v[176:179], v[44:47]
    ds_read_b64_tr_b16 v[220:221], v26 offset:3872
    ds_read_b64_tr_b16 v[222:223], v26 offset:3840
    s_waitcnt lgkmcnt(12)
    v_mfma_f32_16x16x32_bf16 v[40:43], v[180:183], v[184:187], v[40:43]
    v_add_f32_dpp v14, v31, v34 wave_ror:1 row_mask:0xf bank_mask:0xf
    v_add_f32_dpp v15, v35, v38 wave_ror:1 row_mask:0xf bank_mask:0xf
    v_add_f32_dpp v13, v31, v30 wave_shr:1 row_mask:0xf bank_mask:0xf bound_ctrl:0
    v_add_f32_dpp v14, v35, v34 wave_shr:1 row_mask:0xf bank_mask:0xf
    v_add_f32_dpp v15, v39, v38 wave_shr:1 row_mask:0xf bank_mask:0xf
    v_mfma_f32_16x16x32_bf16 v[44:47], v[168:171], v[184:187], v[44:47]
    v_add_f32_dpp v34, v13, v33 wave_ror:1 row_mask:0xf bank_mask:0xf
    v_add_f32_dpp v38, v14, v37 wave_ror:1 row_mask:0xf bank_mask:0xf
    v_add_f32_dpp v30, v13, v29 wave_shr:1 row_mask:0xf bank_mask:0xf bound_ctrl:0
    s_waitcnt lgkmcnt(11)
    v_mfma_f32_16x16x32_bf16 v[48:51], v[188:191], v[252:255], 0
    v_add_f32_dpp v34, v14, v33 wave_shr:1 row_mask:0xf bank_mask:0xf
    v_add_f32_dpp v38, v15, v37 wave_shr:1 row_mask:0xf bank_mask:0xf
    v_add_f32_dpp v33, v30, v32 wave_ror:1 row_mask:0xf bank_mask:0xf
    s_waitcnt lgkmcnt(10)
    v_mfma_f32_16x16x32_bf16 v[52:55], v[192:195], v[252:255], 0
    v_add_f32_dpp v37, v34, v36 wave_ror:1 row_mask:0xf bank_mask:0xf
    v_add_f32_dpp v33, v34, v32 wave_shr:1 row_mask:0xf bank_mask:0xf
    s_nop 0
    v_add_f32_dpp v37, v38, v36 wave_shr:1 row_mask:0xf bank_mask:0xf
    v_mfma_f32_16x16x32_bf16 v[48:51], v[132:135], v[248:251], v[48:51]
    v_add_f32_dpp v10, v39, v42 wave_ror:1 row_mask:0xf bank_mask:0xf
    v_add_f32_dpp v11, v43, v46 wave_ror:1 row_mask:0xf bank_mask:0xf
    v_mfma_f32_16x16x32_bf16 v[52:55], v[136:139], v[248:251], v[52:55]
    v_add_f32_dpp v10, v43, v42 wave_shr:1 row_mask:0xf bank_mask:0xf
    v_add_f32_dpp v11, v47, v46 wave_shr:1 row_mask:0xf bank_mask:0xf
    v_mfma_f32_16x16x32_bf16 v[48:51], v[124:127], v[244:247], v[48:51]
    v_add_f32_dpp v42, v15, v41 wave_ror:1 row_mask:0xf bank_mask:0xf
    v_add_f32_dpp v46, v10, v45 wave_ror:1 row_mask:0xf bank_mask:0xf
    v_mfma_f32_16x16x32_bf16 v[52:55], v[128:131], v[244:247], v[52:55]
    v_add_f32_dpp v42, v10, v41 wave_shr:1 row_mask:0xf bank_mask:0xf
    v_add_f32_dpp v46, v11, v45 wave_shr:1 row_mask:0xf bank_mask:0xf
    v_mfma_f32_16x16x32_bf16 v[48:51], v[116:119], v[240:243], v[48:51]
    v_add_f32_dpp v41, v38, v40 wave_ror:1 row_mask:0xf bank_mask:0xf
    v_add_f32_dpp v45, v42, v44 wave_ror:1 row_mask:0xf bank_mask:0xf
    v_mfma_f32_16x16x32_bf16 v[52:55], v[120:123], v[240:243], v[52:55]
    v_add_f32_dpp v41, v42, v40 wave_shr:1 row_mask:0xf bank_mask:0xf
    v_add_f32_dpp v45, v46, v44 wave_shr:1 row_mask:0xf bank_mask:0xf
    v_mfma_f32_16x16x32_bf16 v[48:51], v[108:111], v[236:239], v[48:51]
    s_mov_b32 m0, s40
    s_nop 0
    ds_write_addtid_b32 v33 offset:0
    ds_write_addtid_b32 v37 offset:256
    ds_write_addtid_b32 v41 offset:512
    ds_write_addtid_b32 v45 offset:768
    v_mfma_f32_16x16x32_bf16 v[52:55], v[112:115], v[236:239], v[52:55]
    v_mfma_f32_16x16x32_bf16 v[48:51], v[100:103], v[232:235], v[48:51]
    v_mfma_f32_16x16x32_bf16 v[52:55], v[104:107], v[232:235], v[52:55]
    v_mfma_f32_16x16x32_bf16 v[48:51], v[92:95], v[228:231], v[48:51]
    s_waitcnt lgkmcnt(0)
    s_barrier
    v_mfma_f32_16x16x32_bf16 v[52:55], v[96:99], v[228:231], v[52:55]
    v_mfma_f32_16x16x32_bf16 v[48:51], v[84:87], v[224:227], v[48:51]
    v_mfma_f32_16x16x32_bf16 v[52:55], v[88:91], v[224:227], v[52:55]
    v_mfma_f32_16x16x32_bf16 v[48:51], v[76:79], v[140:143], v[48:51]
    v_mfma_f32_16x16x32_bf16 v[52:55], v[80:83], v[140:143], v[52:55]
    v_mfma_f32_16x16x32_bf16 v[48:51], v[68:71], v[152:155], v[48:51]
    v_mfma_f32_16x16x32_bf16 v[52:55], v[72:75], v[152:155], v[52:55]
    v_mfma_f32_16x16x32_bf16 v[48:51], v[148:151], v[164:167], v[48:51]
    v_mfma_f32_16x16x32_bf16 v[52:55], v[64:67], v[164:167], v[52:55]
    v_mfma_f32_16x16x32_bf16 v[48:51], v[160:163], v[176:179], v[48:51]
    v_mfma_f32_16x16x32_bf16 v[52:55], v[144:147], v[176:179], v[52:55]
    v_mfma_f32_16x16x32_bf16 v[48:51], v[172:175], v[184:187], v[48:51]
    v_mfma_f32_16x16x32_bf16 v[52:55], v[156:159], v[184:187], v[52:55]
    v_mfma_f32_16x16x32_bf16 v[48:51], v[180:183], v[196:199], v[48:51]
    v_mfma_f32_16x16x32_bf16 v[52:55], v[168:171], v[196:199], v[52:55]
    v_mfma_f32_16x16x32_bf16 v[56:59], v[200:203], v[252:255], 0
    v_mfma_f32_16x16x32_bf16 v[60:63], v[204:207], v[252:255], 0
    v_mfma_f32_16x16x32_bf16 v[56:59], v[188:191], v[248:251], v[56:59]
    s_nop 3
    v_add_f32_dpp v12, v47, v50 wave_ror:1 row_mask:0xf bank_mask:0xf
    v_add_f32_dpp v13, v51, v54 wave_ror:1 row_mask:0xf bank_mask:0xf
    v_mfma_f32_16x16x32_bf16 v[60:63], v[192:195], v[248:251], v[60:63]
    v_add_f32_dpp v12, v51, v50 wave_shr:1 row_mask:0xf bank_mask:0xf
    v_add_f32_dpp v13, v55, v54 wave_shr:1 row_mask:0xf bank_mask:0xf
    v_mfma_f32_16x16x32_bf16 v[56:59], v[132:135], v[244:247], v[56:59]
    v_add_f32_dpp v50, v11, v49 wave_ror:1 row_mask:0xf bank_mask:0xf
    v_add_f32_dpp v54, v12, v53 wave_ror:1 row_mask:0xf bank_mask:0xf
    v_mfma_f32_16x16x32_bf16 v[60:63], v[136:139], v[244:247], v[60:63]
    v_add_f32_dpp v50, v12, v49 wave_shr:1 row_mask:0xf bank_mask:0xf
    v_add_f32_dpp v54, v13, v53 wave_shr:1 row_mask:0xf bank_mask:0xf
    v_mfma_f32_16x16x32_bf16 v[56:59], v[124:127], v[240:243], v[56:59]
    v_add_f32_dpp v49, v46, v48 wave_ror:1 row_mask:0xf bank_mask:0xf
    v_add_f32_dpp v53, v50, v52 wave_ror:1 row_mask:0xf bank_mask:0xf
    v_mfma_f32_16x16x32_bf16 v[60:63], v[128:131], v[240:243], v[60:63]
    v_add_f32_dpp v49, v50, v48 wave_shr:1 row_mask:0xf bank_mask:0xf
    v_add_f32_dpp v53, v54, v52 wave_shr:1 row_mask:0xf bank_mask:0xf
    v_mfma_f32_16x16x32_bf16 v[56:59], v[116:119], v[236:239], v[56:59]
    ds_write_addtid_b32 v49 offset:1024
    ds_write_addtid_b32 v53 offset:1280
    v_mfma_f32_16x16x32_bf16 v[60:63], v[120:123], v[236:239], v[60:63]
    v_mfma_f32_16x16x32_bf16 v[56:59], v[108:111], v[232:235], v[56:59]
    v_mfma_f32_16x16x32_bf16 v[60:63], v[112:115], v[232:235], v[60:63]
    v_mfma_f32_16x16x32_bf16 v[56:59], v[100:103], v[228:231], v[56:59]
    s_waitcnt lgkmcnt(0)
    s_barrier
    v_mfma_f32_16x16x32_bf16 v[60:63], v[104:107], v[228:231], v[60:63]
    v_mfma_f32_16x16x32_bf16 v[56:59], v[92:95], v[224:227], v[56:59]
    v_mfma_f32_16x16x32_bf16 v[60:63], v[96:99], v[224:227], v[60:63]
    v_mfma_f32_16x16x32_bf16 v[56:59], v[84:87], v[140:143], v[56:59]
    v_mfma_f32_16x16x32_bf16 v[60:63], v[88:91], v[140:143], v[60:63]
    v_mfma_f32_16x16x32_bf16 v[56:59], v[76:79], v[152:155], v[56:59]
    v_mfma_f32_16x16x32_bf16 v[60:63], v[80:83], v[152:155], v[60:63]
    v_mfma_f32_16x16x32_bf16 v[56:59], v[68:71], v[164:167], v[56:59]
    v_mfma_f32_16x16x32_bf16 v[60:63], v[72:75], v[164:167], v[60:63]
    v_mfma_f32_16x16x32_bf16 v[56:59], v[148:151], v[176:179], v[56:59]
    v_mfma_f32_16x16x32_bf16 v[60:63], v[64:67], v[176:179], v[60:63]
    v_mfma_f32_16x16x32_bf16 v[56:59], v[160:163], v[184:187], v[56:59]
    v_mfma_f32_16x16x32_bf16 v[60:63], v[144:147], v[184:187], v[60:63]
    v_mfma_f32_16x16x32_bf16 v[56:59], v[172:175], v[196:199], v[56:59]
    v_mfma_f32_16x16x32_bf16 v[60:63], v[156:159], v[196:199], v[60:63]
    v_mfma_f32_16x16x32_bf16 v[56:59], v[180:183], v[208:211], v[56:59]
    v_mfma_f32_16x16x32_bf16 v[60:63], v[168:171], v[208:211], v[60:63]
    v_mfma_f32_16x16x32_bf16 v[20:23], v[212:215], v[252:255], 0
    v_mfma_f32_16x16x32_bf16 v[2:5], v[216:219], v[252:255], 0
    v_mfma_f32_16x16x32_bf16 v[20:23], v[200:203], v[248:251], v[20:23]
    s_nop 3
    v_add_f32_dpp v14, v55, v58 wave_ror:1 row_mask:0xf bank_mask:0xf
    v_add_f32_dpp v15, v59, v62 wave_ror:1 row_mask:0xf bank_mask:0xf
    v_mfma_f32_16x16x32_bf16 v[2:5], v[204:207], v[248:251], v[2:5]
    v_add_f32_dpp v14, v59, v58 wave_shr:1 row_mask:0xf bank_mask:0xf
    v_add_f32_dpp v15, v63, v62 wave_shr:1 row_mask:0xf bank_mask:0xf
    v_mfma_f32_16x16x32_bf16 v[20:23], v[188:191], v[244:247], v[20:23]
    v_add_f32_dpp v58, v13, v57 wave_ror:1 row_mask:0xf bank_mask:0xf
    v_add_f32_dpp v62, v14, v61 wave_ror:1 row_mask:0xf bank_mask:0xf
    v_mfma_f32_16x16x32_bf16 v[2:5], v[192:195], v[244:247], v[2:5]
    v_add_f32_dpp v58, v14, v57 wave_shr:1 row_mask:0xf bank_mask:0xf
    v_add_f32_dpp v62, v15, v61 wave_shr:1 row_mask:0xf bank_mask:0xf
    v_mfma_f32_16x16x32_bf16 v[20:23], v[132:135], v[240:243], v[20:23]
    v_add_f32_dpp v57, v54, v56 wave_ror:1 row_mask:0xf bank_mask:0xf
    v_add_f32_dpp v61, v58, v60 wave_ror:1 row_mask:0xf bank_mask:0xf
    v_mfma_f32_16x16x32_bf16 v[2:5], v[136:139], v[240:243], v[2:5]
    v_add_f32_dpp v57, v58, v56 wave_shr:1 row_mask:0xf bank_mask:0xf
    v_add_f32_dpp v61, v62, v60 wave_shr:1 row_mask:0xf bank_mask:0xf
    v_mfma_f32_16x16x32_bf16 v[20:23], v[124:127], v[236:239], v[20:23]
    ds_write_addtid_b32 v57 offset:1536
    ds_write_addtid_b32 v61 offset:1792
    v_mfma_f32_16x16x32_bf16 v[2:5], v[128:131], v[236:239], v[2:5]
    v_mfma_f32_16x16x32_bf16 v[20:23], v[116:119], v[232:235], v[20:23]
    v_mfma_f32_16x16x32_bf16 v[2:5], v[120:123], v[232:235], v[2:5]
    v_mfma_f32_16x16x32_bf16 v[20:23], v[108:111], v[228:231], v[20:23]
    s_waitcnt lgkmcnt(0)
    s_barrier
    v_mfma_f32_16x16x32_bf16 v[2:5], v[112:115], v[228:231], v[2:5]
    v_mfma_f32_16x16x32_bf16 v[20:23], v[100:103], v[224:227], v[20:23]
    v_mfma_f32_16x16x32_bf16 v[2:5], v[104:107], v[224:227], v[2:5]
    v_mfma_f32_16x16x32_bf16 v[20:23], v[92:95], v[140:143], v[20:23]
    v_mfma_f32_16x16x32_bf16 v[2:5], v[96:99], v[140:143], v[2:5]
    v_mfma_f32_16x16x32_bf16 v[20:23], v[84:87], v[152:155], v[20:23]
    v_mfma_f32_16x16x32_bf16 v[2:5], v[88:91], v[152:155], v[2:5]
    v_mfma_f32_16x16x32_bf16 v[20:23], v[76:79], v[164:167], v[20:23]
    v_mfma_f32_16x16x32_bf16 v[2:5], v[80:83], v[164:167], v[2:5]
    v_mfma_f32_16x16x32_bf16 v[20:23], v[68:71], v[176:179], v[20:23]
    v_mfma_f32_16x16x32_bf16 v[2:5], v[72:75], v[176:179], v[2:5]
    v_mfma_f32_16x16x32_bf16 v[20:23], v[148:151], v[184:187], v[20:23]
    v_mfma_f32_16x16x32_bf16 v[2:5], v[64:67], v[184:187], v[2:5]
    v_mfma_f32_16x16x32_bf16 v[20:23], v[160:163], v[196:199], v[20:23]
    v_mfma_f32_16x16x32_bf16 v[2:5], v[144:147], v[196:199], v[2:5]
    v_mfma_f32_16x16x32_bf16 v[20:23], v[172:175], v[208:211], v[20:23]
    v_mfma_f32_16x16x32_bf16 v[2:5], v[156:159], v[208:211], v[2:5]
    v_mfma_f32_16x16x32_bf16 v[20:23], v[180:183], v[220:223], v[20:23]
    v_mfma_f32_16x16x32_bf16 v[2:5], v[168:171], v[220:223], v[2:5]
    s_nop 6
    v_add_f32_dpp v10, v63, v22 wave_ror:1 row_mask:0xf bank_mask:0xf
    v_add_f32_dpp v11, v23, v4 wave_ror:1 row_mask:0xf bank_mask:0xf
    s_nop 0
    v_add_f32_dpp v10, v23, v22 wave_shr:1 row_mask:0xf bank_mask:0xf
    v_add_f32_dpp v11, v5, v4 wave_shr:1 row_mask:0xf bank_mask:0xf
    v_add_f32_dpp v22, v15, v21 wave_ror:1 row_mask:0xf bank_mask:0xf
    v_add_f32_dpp v4, v10, v3 wave_ror:1 row_mask:0xf bank_mask:0xf
    s_nop 0
    v_add_f32_dpp v22, v10, v21 wave_shr:1 row_mask:0xf bank_mask:0xf
    v_add_f32_dpp v4, v11, v3 wave_shr:1 row_mask:0xf bank_mask:0xf
    v_add_f32_dpp v21, v62, v20 wave_ror:1 row_mask:0xf bank_mask:0xf
    v_add_f32_dpp v3, v22, v2 wave_ror:1 row_mask:0xf bank_mask:0xf
    s_nop 0
    v_add_f32_dpp v21, v22, v20 wave_shr:1 row_mask:0xf bank_mask:0xf
    v_add_f32_dpp v3, v4, v2 wave_shr:1 row_mask:0xf bank_mask:0xf
    ds_write_addtid_b32 v21 offset:2048
    ds_write_addtid_b32 v3 offset:2304
    s_waitcnt lgkmcnt(0)
    s_barrier
    s_endpgm
.p2align 6
L_M1:
    s_barrier
    v_mfma_f32_16x16x32_f16 v[180:183], v[144:147], v[96:99], v[180:183]
    v_mfma_f32_16x16x32_f16 v[188:191], v[160:163], v[96:99], v[188:191]
    ds_read_b128 v[192:195], v3 offset:43008
    ds_read_b128 v[196:199], v3 offset:44032
    ds_read_b128 v[200:203], v3 offset:45056
    ds_read_b128 v[204:207], v3 offset:46080
    ds_read_b64_tr_b16 v[224:225], v26 offset:32
    v_mfma_f32_16x16x32_f16 v[180:183], v[148:151], v[100:103], v[180:183]
    v_mfma_f32_16x16x32_f16 v[188:191], v[164:167], v[100:103], v[188:191]
    ds_read_b64_tr_b16 v[226:227], v26 offset:0
    ds_read_b64_tr_b16 v[228:229], v26 offset:288
    ds_read_b64_tr_b16 v[230:231], v26 offset:256
    ds_read_b64_tr_b16 v[232:233], v26 offset:544
    ds_read_b64_tr_b16 v[234:235], v26 offset:512
    v_mfma_f32_16x16x32_f16 v[180:183], v[152:155], v[104:107], v[180:183]
    v_mfma_f32_16x16x32_f16 v[188:191], v[168:171], v[104:107], v[188:191]
    ds_read_b64_tr_b16 v[236:237], v26 offset:800
    ds_read_b64_tr_b16 v[238:239], v26 offset:768
    ds_read_b64_tr_b16 v[240:241], v26 offset:1056
    ds_read_b64_tr_b16 v[242:243], v26 offset:1024
    ds_read_b64_tr_b16 v[244:245], v26 offset:1312
    v_mfma_f32_16x16x32_f16 v[180:183], v[156:159], v[108:111], v[180:183]
    v_mfma_f32_16x16x32_f16 v[188:191], v[172:175], v[108:111], v[188:191]
    ds_read_b64_tr_b16 v[246:247], v26 offset:1280
    ds_read_b64_tr_b16 v[248:249], v26 offset:1568
    ds_read_b64_tr_b16 v[250:251], v26 offset:1536
    ds_read_b64_tr_b16 v[252:253], v26 offset:1824
    ds_read_b64_tr_b16 v[254:255], v26 offset:1792
    s_waitcnt lgkmcnt(15)
    v_fma_f32 v176, v176, v18, v192
    v_fma_f32 v177, v177, v18, v193
    v_fma_f32 v180, v180, v18, v196
    v_fma_f32 v181, v181, v18, v197
    v_cvt_pk_bf16_f32 v223, v176, v177
    v_cvt_pk_bf16_f32 v17, v180, v181
    v_fma_f32 v179, v179, v18, v195
    v_fma_f32 v183, v183, v18, v199
    v_permlane16_swap_b32 v223, v17
    ds_write_b32 v25, v223 offset:128
    ds_write_b32 v25, v17 offset:1312
    ds_read2_b64 v[64:67], v24 offset0:0 offset1:1
    ds_read2_b64 v[68:71], v24 offset0:4 offset1:5
    s_waitcnt lgkmcnt(1)
    v_mfma_f32_16x16x32_bf16 v[28:31], v[64:67], v[224:227], 0
    ds_read2_b64 v[72:75], v24 offset0:8 offset1:9
    ds_read2_b64 v[76:79], v24 offset0:12 offset1:13
    s_waitcnt lgkmcnt(2)
    v_mfma_f32_16x16x32_bf16 v[32:35], v[68:71], v[224:227], 0
    v_fma_f32 v178, v178, v18, v194
    v_mfma_f32_16x16x32_bf16 v[36:39], v[64:67], v[228:231], 0
    v_fma_f32 v182, v182, v18, v198
    v_permlane16_swap_b32 v179, v183
    v_fma_f32 v184, v184, v18, v200
    v_permlane16_swap_b32 v178, v182
    v_mov_b32 v210, v183
    v_fma_f32 v188, v188, v18, v204
    v_cvt_pk_bf16_f32 v208, v178, v179
    v_mov_b32_dpp v210, v184 wave_rol:1 row_mask:0x8 bank_mask:0xf
    v_fma_f32 v185, v185, v18, v201
    ds_write_b32 v25, v208 offset:256
    v_mov_b32_dpp v210, v183 wave_shl:1 row_mask:0xc bank_mask:0xf
    v_fma_f32 v189, v189, v18, v205
    v_cvt_pk_bf16_f32 v209, v182, v210
    ds_write_b32 v25, v209 offset:1440
    ds_read2_b64 v[80:83], v24 offset0:16 offset1:17
    s_waitcnt lgkmcnt(4)
    v_mfma_f32_16x16x32_bf16 v[36:39], v[72:75], v[224:227], v[36:39]
    v_mfma_f32_16x16x32_bf16 v[40:43], v[68:71], v[228:231], 0
    v_add_f32_dpp v11, v31, v34 wave_ror:1 row_mask:0xf bank_mask:0xf
    v_permlane16_swap_b32 v184, v188
    s_waitcnt lgkmcnt(3)
    v_mfma_f32_16x16x32_bf16 v[40:43], v[76:79], v[224:227], v[40:43]
    ds_read2_b64 v[84:87], v24 offset0:20 offset1:21
    v_add_f32_dpp v10, v31, v30 wave_shr:1 row_mask:0xf bank_mask:0xf bound_ctrl:0
    v_add_f32_dpp v11, v35, v34 wave_shr:1 row_mask:0xf bank_mask:0xf
    v_mfma_f32_16x16x32_bf16 v[44:47], v[64:67], v[232:235], 0
    v_add_f32_dpp v34, v10, v33 wave_ror:1 row_mask:0xf bank_mask:0xf
    v_mfma_f32_16x16x32_bf16 v[44:47], v[72:75], v[228:231], v[44:47]
    v_add_f32_dpp v30, v10, v29 wave_shr:1 row_mask:0xf bank_mask:0xf bound_ctrl:0
    v_add_f32_dpp v34, v11, v33 wave_shr:1 row_mask:0xf bank_mask:0xf
    s_waitcnt lgkmcnt(1)
    v_mfma_f32_16x16x32_bf16 v[44:47], v[80:83], v[224:227], v[44:47]
    v_add_f32_dpp v33, v30, v32 wave_ror:1 row_mask:0xf bank_mask:0xf
    v_permlane16_swap_b32 v185, v189
    v_mfma_f32_16x16x32_bf16 v[48:51], v[68:71], v[232:235], 0
    ds_read2_b64 v[88:91], v24 offset0:24 offset1:25
    v_add_f32_dpp v29, v30, v28 wave_shr:1 row_mask:0xf bank_mask:0xf bound_ctrl:0
    v_add_f32_dpp v33, v34, v32 wave_shr:1 row_mask:0xf bank_mask:0xf
    v_mfma_f32_16x16x32_bf16 v[48:51], v[76:79], v[228:231], v[48:51]
    v_add_f32_dpp v12, v35, v38 wave_ror:1 row_mask:0xf bank_mask:0xf
    v_add_f32_dpp v13, v39, v42 wave_ror:1 row_mask:0xf bank_mask:0xf
    s_waitcnt lgkmcnt(1)
    v_mfma_f32_16x16x32_bf16 v[48:51], v[84:87], v[224:227], v[48:51]
    v_add_f32_dpp v12, v39, v38 wave_shr:1 row_mask:0xf bank_mask:0xf
    v_add_f32_dpp v13, v43, v42 wave_shr:1 row_mask:0xf bank_mask:0xf
    v_mfma_f32_16x16x32_bf16 v[52:55], v[64:67], v[236:239], 0
    v_add_f32_dpp v38, v11, v37 wave_ror:1 row_mask:0xf bank_mask:0xf
    v_add_f32_dpp v42, v12, v41 wave_ror:1 row_mask:0xf bank_mask:0xf
    v_mfma_f32_16x16x32_bf16 v[52:55], v[72:75], v[232:235], v[52:55]
    ds_read2_b64 v[92:95], v24 offset0:28 offset1:29
    v_add_f32_dpp v38, v12, v37 wave_shr:1 row_mask:0xf bank_mask:0xf
    v_add_f32_dpp v42, v13, v41 wave_shr:1 row_mask:0xf bank_mask:0xf
    v_mfma_f32_16x16x32_bf16 v[52:55], v[80:83], v[228:231], v[52:55]
    v_add_f32_dpp v37, v34, v36 wave_ror:1 row_mask:0xf bank_mask:0xf
    v_add_f32_dpp v41, v38, v40 wave_ror:1 row_mask:0xf bank_mask:0xf
    s_waitcnt lgkmcnt(1)
    v_mfma_f32_16x16x32_bf16 v[52:55], v[88:91], v[224:227], v[52:55]
    v_add_f32_dpp v37, v38, v36 wave_shr:1 row_mask:0xf bank_mask:0xf
    v_add_f32_dpp v41, v42, v40 wave_shr:1 row_mask:0xf bank_mask:0xf
    v_mfma_f32_16x16x32_bf16 v[56:59], v[68:71], v[236:239], 0
    s_mov_b32 m0, s40
    s_nop 0
    ds_write_addtid_b32 v29 offset:0
    ds_write_addtid_b32 v33 offset:256
    ds_write_addtid_b32 v37 offset:512
    ds_write_addtid_b32 v41 offset:768
    v_mfma_f32_16x16x32_bf16 v[56:59], v[76:79], v[232:235], v[56:59]
    v_mfma_f32_16x16x32_bf16 v[56:59], v[84:87], v[228:231], v[56:59]
    v_fma_f32 v186, v186, v18, v202
    v_mov_b32_dpp v211, v188 wave_rol:1 row_mask:0xf bank_mask:0xf
    v_cvt_pk_bf16_f32 v212, v184, v185
    s_nop 0
    v_mov_b32_dpp v211, v184 wave_shl:1 row_mask:0xf bank_mask:0xf
    s_mov_b32 m0, s3
    s_nop 0
    ds_write_addtid_b32 v212 offset:45440
    ds_write_addtid_b32 v212 offset:46624
    v_cvt_pk_bf16_f32 v213, v184, v211
    v_cvt_pk_bf16_f32 v214, v185, v211
    ds_write_addtid_b32 v213 offset:47808
    ds_write_addtid_b32 v214 offset:48992
    ds_read2_b64 v[96:99], v24 offset0:32 offset1:33
    s_waitcnt lgkmcnt(9)
    v_mfma_f32_16x16x32_bf16 v[56:59], v[92:95], v[224:227], v[56:59]
    v_mfma_f32_16x16x32_bf16 v[60:63], v[64:67], v[240:243], 0
    s_waitcnt lgkmcnt(5)
    s_barrier
    v_add_f32_dpp v14, v43, v46 wave_ror:1 row_mask:0xf bank_mask:0xf
    v_add_f32_dpp v15, v47, v50 wave_ror:1 row_mask:0xf bank_mask:0xf
    v_mfma_f32_16x16x32_bf16 v[60:63], v[72:75], v[236:239], v[60:63]
    v_add_f32_dpp v14, v47, v46 wave_shr:1 row_mask:0xf bank_mask:0xf
    v_add_f32_dpp v15, v51, v50 wave_shr:1 row_mask:0xf bank_mask:0xf
    v_mfma_f32_16x16x32_bf16 v[60:63], v[80:83], v[232:235], v[60:63]
    v_add_f32_dpp v46, v13, v45 wave_ror:1 row_mask:0xf bank_mask:0xf
    v_add_f32_dpp v50, v14, v49 wave_ror:1 row_mask:0xf bank_mask:0xf
    v_mfma_f32_16x16x32_bf16 v[60:63], v[88:91], v[228:231], v[60:63]
    ds_read2_b64 v[100:103], v24 offset0:36 offset1:37
    v_add_f32_dpp v46, v14, v45 wave_shr:1 row_mask:0xf bank_mask:0xf
    v_add_f32_dpp v50, v15, v49 wave_shr:1 row_mask:0xf bank_mask:0xf
    s_waitcnt lgkmcnt(1)
    v_mfma_f32_16x16x32_bf16 v[60:63], v[96:99], v[224:227], v[60:63]
    v_add_f32_dpp v45, v42, v44 wave_ror:1 row_mask:0xf bank_mask:0xf
    v_add_f32_dpp v49, v46, v48 wave_ror:1 row_mask:0xf bank_mask:0xf
    v_mfma_f32_16x16x32_bf16 v[20:23], v[68:71], v[240:243], 0
    v_add_f32_dpp v45, v46, v44 wave_shr:1 row_mask:0xf bank_mask:0xf
    v_add_f32_dpp v49, v50, v48 wave_shr:1 row_mask:0xf bank_mask:0xf
    v_mfma_f32_16x16x32_bf16 v[20:23], v[76:79], v[236:239], v[20:23]
    v_add_f32_dpp v10, v51, v54 wave_ror:1 row_mask:0xf bank_mask:0xf
    v_add_f32_dpp v11, v55, v58 wave_ror:1 row_mask:0xf bank_mask:0xf
    v_mfma_f32_16x16x32_bf16 v[20:23], v[84:87], v[232:235], v[20:23]
    v_add_f32_dpp v10, v55, v54 wave_shr:1 row_mask:0xf bank_mask:0xf
    v_add_f32_dpp v11, v59, v58 wave_shr:1 row_mask:0xf bank_mask:0xf
    v_mov_b32_dpp v215, v189 wave_rol:1 row_mask:0xf bank_mask:0xf
    v_mfma_f32_16x16x32_bf16 v[20:23], v[92:95], v[228:231], v[20:23]
    v_add_f32_dpp v54, v15, v53 wave_ror:1 row_mask:0xf bank_mask:0xf
    v_add_f32_dpp v58, v10, v57 wave_ror:1 row_mask:0xf bank_mask:0xf
    v_mov_b32_dpp v215, v188 wave_shl:1 row_mask:0xf bank_mask:0xf
    s_waitcnt lgkmcnt(0)
    v_mfma_f32_16x16x32_bf16 v[20:23], v[100:103], v[224:227], v[20:23]
    ds_read2_b64 v[104:107], v24 offset0:40 offset1:41
    v_add_f32_dpp v54, v10, v53 wave_shr:1 row_mask:0xf bank_mask:0xf
    v_add_f32_dpp v58, v11, v57 wave_shr:1 row_mask:0xf bank_mask:0xf
    v_mfma_f32_16x16x32_bf16 v[2:5], v[64:67], v[244:247], 0
    v_add_f32_dpp v53, v50, v52 wave_ror:1 row_mask:0xf bank_mask:0xf
    v_add_f32_dpp v57, v54, v56 wave_ror:1 row_mask:0xf bank_mask:0xf
    v_mfma_f32_16x16x32_bf16 v[2:5], v[72:75], v[240:243], v[2:5]
    v_add_f32_dpp v53, v54, v52 wave_shr:1 row_mask:0xf bank_mask:0xf
    v_add_f32_dpp v57, v58, v56 wave_shr:1 row_mask:0xf bank_mask:0xf
    v_mfma_f32_16x16x32_bf16 v[2:5], v[80:83], v[236:239], v[2:5]
    s_mov_b32 m0, s40
    s_nop 0
    ds_write_addtid_b32 v45 offset:1024
    ds_write_addtid_b32 v49 offset:1280
    ds_write_addtid_b32 v53 offset:1536
    ds_write_addtid_b32 v57 offset:1792
    v_mfma_f32_16x16x32_bf16 v[2:5], v[88:91], v[232:235], v[2:5]
    v_mfma_f32_16x16x32_bf16 v[2:5], v[96:99], v[228:231], v[2:5]
    v_cvt_pk_bf16_f32 v217, v188, v215
    v_bfi_b32 v216, v27, v215, v188
    s_waitcnt lgkmcnt(4)
    v_mfma_f32_16x16x32_bf16 v[2:5], v[104:107], v[224:227], v[2:5]
    ds_read2_b64 v[108:111], v24 offset0:44 offset1:45
    v_mfma_f32_16x16x32_bf16 v[6:9], v[68:71], v[244:247], 0
    s_waitcnt lgkmcnt(1)
    s_barrier
    v_add_f32_dpp v12, v59, v62 wave_ror:1 row_mask:0xf bank_mask:0xf
    v_add_f32_dpp v13, v63, v22 wave_ror:1 row_mask:0xf bank_mask:0xf
    v_mfma_f32_16x16x32_bf16 v[6:9], v[76:79], v[240:243], v[6:9]
    v_add_f32_dpp v12, v63, v62 wave_shr:1 row_mask:0xf bank_mask:0xf
    v_add_f32_dpp v13, v23, v22 wave_shr:1 row_mask:0xf bank_mask:0xf
    v_mfma_f32_16x16x32_bf16 v[6:9], v[84:87], v[236:239], v[6:9]
    v_add_f32_dpp v62, v11, v61 wave_ror:1 row_mask:0xf bank_mask:0xf
    v_add_f32_dpp v22, v12, v21 wave_ror:1 row_mask:0xf bank_mask:0xf
    v_mfma_f32_16x16x32_bf16 v[6:9], v[92:95], v[232:235], v[6:9]
    v_add_f32_dpp v62, v12, v61 wave_shr:1 row_mask:0xf bank_mask:0xf
    v_add_f32_dpp v22, v13, v21 wave_shr:1 row_mask:0xf bank_mask:0xf
    s_mov_b32 m0, s3
    s_nop 0
    ds_write_addtid_b32 v217 offset:46880
    v_mfma_f32_16x16x32_bf16 v[6:9], v[100:103], v[228:231], v[6:9]
    v_add_f32_dpp v61, v58, v60 wave_ror:1 row_mask:0xf bank_mask:0xf
    v_add_f32_dpp v21, v62, v20 wave_ror:1 row_mask:0xf bank_mask:0xf
    s_waitcnt lgkmcnt(1)
    v_mfma_f32_16x16x32_bf16 v[6:9], v[108:111], v[224:227], v[6:9]
    v_add_f32_dpp v61, v62, v60 wave_shr:1 row_mask:0xf bank_mask:0xf
    v_add_f32_dpp v21, v22, v20 wave_shr:1 row_mask:0xf bank_mask:0xf
    v_mfma_f32_16x16x32_bf16 v[28:31], v[64:67], v[248:251], 0
    ds_read2_b64 v[112:115], v24 offset0:48 offset1:49
    v_mfma_f32_16x16x32_bf16 v[28:31], v[72:75], v[244:247], v[28:31]
    v_mfma_f32_16x16x32_bf16 v[28:31], v[80:83], v[240:243], v[28:31]
    v_add_f32_dpp v14, v23, v4 wave_ror:1 row_mask:0xf bank_mask:0xf
    s_nop 0
    v_add_f32_dpp v15, v5, v8 wave_ror:1 row_mask:0xf bank_mask:0xf
    v_mfma_f32_16x16x32_bf16 v[28:31], v[88:91], v[236:239], v[28:31]
    v_add_f32_dpp v14, v5, v4 wave_shr:1 row_mask:0xf bank_mask:0xf
    v_add_f32_dpp v15, v9, v8 wave_shr:1 row_mask:0xf bank_mask:0xf
    v_cvt_pk_bf16_f32 v218, v188, v216
    v_mfma_f32_16x16x32_bf16 v[28:31], v[96:99], v[232:235], v[28:31]
    v_add_f32_dpp v4, v13, v3 wave_ror:1 row_mask:0xf bank_mask:0xf
    v_add_f32_dpp v8, v14, v7 wave_ror:1 row_mask:0xf bank_mask:0xf
    ds_write_addtid_b32 v217 offset:48064
    v_mfma_f32_16x16x32_bf16 v[28:31], v[104:107], v[228:231], v[28:31]
    v_add_f32_dpp v4, v14, v3 wave_shr:1 row_mask:0xf bank_mask:0xf
    v_add_f32_dpp v8, v15, v7 wave_shr:1 row_mask:0xf bank_mask:0xf
    s_waitcnt lgkmcnt(1)
    v_mfma_f32_16x16x32_bf16 v[28:31], v[112:115], v[224:227], v[28:31]
    v_add_f32_dpp v3, v22, v2 wave_ror:1 row_mask:0xf bank_mask:0xf
    v_add_f32_dpp v7, v4, v6 wave_ror:1 row_mask:0xf bank_mask:0xf
    v_mfma_f32_16x16x32_bf16 v[32:35], v[68:71], v[248:251], 0
    ds_read2_b64 v[116:119], v24 offset0:52 offset1:53
    v_add_f32_dpp v3, v4, v2 wave_shr:1 row_mask:0xf bank_mask:0xf
    v_add_f32_dpp v7, v8, v6 wave_shr:1 row_mask:0xf bank_mask:0xf
    v_mfma_f32_16x16x32_bf16 v[32:35], v[76:79], v[244:247], v[32:35]
    s_mov_b32 m0, s40
    s_nop 0
    ds_write_addtid_b32 v61 offset:2048
    ds_write_addtid_b32 v21 offset:2304
    ds_write_addtid_b32 v3 offset:2560
    ds_write_addtid_b32 v7 offset:2816
    v_mfma_f32_16x16x32_bf16 v[32:35], v[84:87], v[240:243], v[32:35]
    v_mfma_f32_16x16x32_bf16 v[32:35], v[92:95], v[236:239], v[32:35]
    s_mov_b32 m0, s3
    s_nop 0
    ds_write_addtid_b32 v217 offset:49248
    v_mfma_f32_16x16x32_bf16 v[32:35], v[100:103], v[232:235], v[32:35]
    v_mfma_f32_16x16x32_bf16 v[32:35], v[108:111], v[228:231], v[32:35]
    s_waitcnt lgkmcnt(1)
    s_barrier
    ds_write_addtid_b32 v218 offset:45696
    v_mfma_f32_16x16x32_bf16 v[32:35], v[116:119], v[224:227], v[32:35]
    ds_read2_b64 v[120:123], v24 offset0:56 offset1:57
    v_mfma_f32_16x16x32_bf16 v[36:39], v[64:67], v[252:255], 0
    ds_read2_b64 v[124:127], v24 offset0:60 offset1:61
    v_mfma_f32_16x16x32_bf16 v[36:39], v[72:75], v[248:251], v[36:39]
    ds_read_b64_tr_b16 v[128:129], v26 offset:2080
    ds_read_b64_tr_b16 v[130:131], v26 offset:2048
    v_mfma_f32_16x16x32_bf16 v[36:39], v[80:83], v[244:247], v[36:39]
    v_add_f32_dpp v10, v9, v30 wave_ror:1 row_mask:0xf bank_mask:0xf
    v_add_f32_dpp v11, v31, v34 wave_ror:1 row_mask:0xf bank_mask:0xf
    v_mfma_f32_16x16x32_bf16 v[36:39], v[88:91], v[240:243], v[36:39]
    v_add_f32_dpp v10, v31, v30 wave_shr:1 row_mask:0xf bank_mask:0xf
    v_add_f32_dpp v11, v35, v34 wave_shr:1 row_mask:0xf bank_mask:0xf
    v_mfma_f32_16x16x32_bf16 v[36:39], v[96:99], v[236:239], v[36:39]
    v_add_f32_dpp v30, v15, v29 wave_ror:1 row_mask:0xf bank_mask:0xf
    v_add_f32_dpp v34, v10, v33 wave_ror:1 row_mask:0xf bank_mask:0xf
    v_mfma_f32_16x16x32_bf16 v[36:39], v[104:107], v[232:235], v[36:39]
    v_add_f32_dpp v30, v10, v29 wave_shr:1 row_mask:0xf bank_mask:0xf
    v_add_f32_dpp v34, v11, v33 wave_shr:1 row_mask:0xf bank_mask:0xf
    ds_read2_b64 v[132:135], v24 offset0:64 offset1:65
    v_mfma_f32_16x16x32_bf16 v[36:39], v[112:115], v[228:231], v[36:39]
    v_add_f32_dpp v29, v8, v28 wave_ror:1 row_mask:0xf bank_mask:0xf
    v_add_f32_dpp v33, v30, v32 wave_ror:1 row_mask:0xf bank_mask:0xf
    s_waitcnt lgkmcnt(4)
    v_mfma_f32_16x16x32_bf16 v[36:39], v[120:123], v[224:227], v[36:39]
    v_add_f32_dpp v29, v30, v28 wave_shr:1 row_mask:0xf bank_mask:0xf
    v_add_f32_dpp v33, v34, v32 wave_shr:1 row_mask:0xf bank_mask:0xf
    v_mfma_f32_16x16x32_bf16 v[40:43], v[68:71], v[252:255], 0
    s_mov_b32 m0, s40
    s_nop 0
    ds_write_addtid_b32 v29 offset:43008
    ds_write_addtid_b32 v33 offset:43264
    v_mfma_f32_16x16x32_bf16 v[40:43], v[76:79], v[248:251], v[40:43]
    v_mfma_f32_16x16x32_bf16 v[40:43], v[84:87], v[244:247], v[40:43]
    ds_read2_b64 v[136:139], v24 offset0:68 offset1:69
    v_mfma_f32_16x16x32_bf16 v[40:43], v[92:95], v[240:243], v[40:43]
    ds_read_b64_tr_b16 v[140:141], v26 offset:2336
    ds_read_b64_tr_b16 v[142:143], v26 offset:2304
    v_mfma_f32_16x16x32_bf16 v[40:43], v[100:103], v[236:239], v[40:43]
    ds_read2_b64 v[144:147], v24 offset0:72 offset1:73
    v_mfma_f32_16x16x32_bf16 v[40:43], v[108:111], v[232:235], v[40:43]
    s_waitcnt lgkmcnt(4)
    s_barrier
    v_mfma_f32_16x16x32_bf16 v[40:43], v[116:119], v[228:231], v[40:43]
    ds_read2_b64 v[148:151], v24 offset0:76 offset1:77
    v_mfma_f32_16x16x32_bf16 v[40:43], v[124:127], v[224:227], v[40:43]
    ds_read_b64_tr_b16 v[152:153], v26 offset:2592
    ds_read_b64_tr_b16 v[154:155], v26 offset:2560
    v_mfma_f32_16x16x32_bf16 v[44:47], v[64:67], v[128:131], 0
    ds_read2_b64 v[156:159], v24 offset0:80 offset1:81
    v_mfma_f32_16x16x32_bf16 v[44:47], v[72:75], v[252:255], v[44:47]
    ds_read2_b64 v[160:163], v24 offset0:84 offset1:85
    v_mfma_f32_16x16x32_bf16 v[44:47], v[80:83], v[248:251], v[44:47]
    v_add_f32_dpp v12, v35, v38 wave_ror:1 row_mask:0xf bank_mask:0xf
    v_add_f32_dpp v13, v39, v42 wave_ror:1 row_mask:0xf bank_mask:0xf
    v_mfma_f32_16x16x32_bf16 v[44:47], v[88:91], v[244:247], v[44:47]
    v_add_f32_dpp v12, v39, v38 wave_shr:1 row_mask:0xf bank_mask:0xf
    v_add_f32_dpp v13, v43, v42 wave_shr:1 row_mask:0xf bank_mask:0xf
    v_mfma_f32_16x16x32_bf16 v[44:47], v[96:99], v[240:243], v[44:47]
    v_add_f32_dpp v38, v11, v37 wave_ror:1 row_mask:0xf bank_mask:0xf
    v_add_f32_dpp v42, v12, v41 wave_ror:1 row_mask:0xf bank_mask:0xf
    v_mfma_f32_16x16x32_bf16 v[44:47], v[104:107], v[236:239], v[44:47]
    v_add_f32_dpp v38, v12, v37 wave_shr:1 row_mask:0xf bank_mask:0xf
    v_add_f32_dpp v42, v13, v41 wave_shr:1 row_mask:0xf bank_mask:0xf
    v_mfma_f32_16x16x32_bf16 v[44:47], v[112:115], v[232:235], v[44:47]
    v_add_f32_dpp v37, v34, v36 wave_ror:1 row_mask:0xf bank_mask:0xf
    v_add_f32_dpp v41, v38, v40 wave_ror:1 row_mask:0xf bank_mask:0xf
    v_mfma_f32_16x16x32_bf16 v[44:47], v[120:123], v[228:231], v[44:47]
    v_add_f32_dpp v37, v38, v36 wave_shr:1 row_mask:0xf bank_mask:0xf
    v_add_f32_dpp v41, v42, v40 wave_shr:1 row_mask:0xf bank_mask:0xf
    v_mfma_f32_16x16x32_bf16 v[44:47], v[132:135], v[224:227], v[44:47]
    ds_write_addtid_b32 v37 offset:43520
    ds_write_addtid_b32 v41 offset:43776
    v_mfma_f32_16x16x32_bf16 v[48:51], v[68:71], v[128:131], 0
    v_mfma_f32_16x16x32_bf16 v[48:51], v[76:79], v[252:255], v[48:51]
    v_mfma_f32_16x16x32_bf16 v[48:51], v[84:87], v[248:251], v[48:51]
    v_mfma_f32_16x16x32_bf16 v[48:51], v[92:95], v[244:247], v[48:51]
    s_waitcnt lgkmcnt(0)
    s_barrier
    v_mfma_f32_16x16x32_bf16 v[48:51], v[100:103], v[240:243], v[48:51]
    v_mfma_f32_16x16x32_bf16 v[48:51], v[108:111], v[236:239], v[48:51]
    v_mfma_f32_16x16x32_bf16 v[48:51], v[116:119], v[232:235], v[48:51]
    v_mfma_f32_16x16x32_bf16 v[48:51], v[124:127], v[228:231], v[48:51]
    v_mfma_f32_16x16x32_bf16 v[48:51], v[136:139], v[224:227], v[48:51]
    v_mfma_f32_16x16x32_bf16 v[52:55], v[64:67], v[140:143], 0
    v_mfma_f32_16x16x32_bf16 v[52:55], v[72:75], v[128:131], v[52:55]
    v_mfma_f32_16x16x32_bf16 v[52:55], v[80:83], v[252:255], v[52:55]
    v_add_f32_dpp v14, v43, v46 wave_ror:1 row_mask:0xf bank_mask:0xf
    s_nop 3
    v_add_f32_dpp v15, v47, v50 wave_ror:1 row_mask:0xf bank_mask:0xf
    v_mfma_f32_16x16x32_bf16 v[52:55], v[88:91], v[248:251], v[52:55]
    v_add_f32_dpp v14, v47, v46 wave_shr:1 row_mask:0xf bank_mask:0xf
    v_add_f32_dpp v15, v51, v50 wave_shr:1 row_mask:0xf bank_mask:0xf
    v_mfma_f32_16x16x32_bf16 v[52:55], v[96:99], v[244:247], v[52:55]
    v_add_f32_dpp v46, v13, v45 wave_ror:1 row_mask:0xf bank_mask:0xf
    v_add_f32_dpp v50, v14, v49 wave_ror:1 row_mask:0xf bank_mask:0xf
    v_mfma_f32_16x16x32_bf16 v[52:55], v[104:107], v[240:243], v[52:55]
    v_add_f32_dpp v46, v14, v45 wave_shr:1 row_mask:0xf bank_mask:0xf
    v_add_f32_dpp v50, v15, v49 wave_shr:1 row_mask:0xf bank_mask:0xf
    v_mfma_f32_16x16x32_bf16 v[52:55], v[112:115], v[236:239], v[52:55]
    v_add_f32_dpp v45, v42, v44 wave_ror:1 row_mask:0xf bank_mask:0xf
    v_add_f32_dpp v49, v46, v48 wave_ror:1 row_mask:0xf bank_mask:0xf
    v_mfma_f32_16x16x32_bf16 v[52:55], v[120:123], v[232:235], v[52:55]
    v_add_f32_dpp v45, v46, v44 wave_shr:1 row_mask:0xf bank_mask:0xf
    v_add_f32_dpp v49, v50, v48 wave_shr:1 row_mask:0xf bank_mask:0xf
    v_mfma_f32_16x16x32_bf16 v[52:55], v[132:135], v[228:231], v[52:55]
    ds_write_addtid_b32 v45 offset:44032
    ds_write_addtid_b32 v49 offset:44288
    v_mfma_f32_16x16x32_bf16 v[52:55], v[144:147], v[224:227], v[52:55]
    v_mfma_f32_16x16x32_bf16 v[56:59], v[68:71], v[140:143], 0
    v_mfma_f32_16x16x32_bf16 v[56:59], v[76:79], v[128:131], v[56:59]
    v_mfma_f32_16x16x32_bf16 v[56:59], v[84:87], v[252:255], v[56:59]
    s_waitcnt lgkmcnt(0)
    s_barrier
    v_mfma_f32_16x16x32_bf16 v[56:59], v[92:95], v[248:251], v[56:59]
    v_mfma_f32_16x16x32_bf16 v[56:59], v[100:103], v[244:247], v[56:59]
    v_mfma_f32_16x16x32_bf16 v[56:59], v[108:111], v[240:243], v[56:59]
    v_mfma_f32_16x16x32_bf16 v[56:59], v[116:119], v[236:239], v[56:59]
    v_mfma_f32_16x16x32_bf16 v[56:59], v[124:127], v[232:235], v[56:59]
    v_mfma_f32_16x16x32_bf16 v[56:59], v[136:139], v[228:231], v[56:59]
    v_mfma_f32_16x16x32_bf16 v[56:59], v[148:151], v[224:227], v[56:59]
    v_mfma_f32_16x16x32_bf16 v[60:63], v[64:67], v[152:155], 0
    v_mfma_f32_16x16x32_bf16 v[60:63], v[72:75], v[140:143], v[60:63]
    v_mfma_f32_16x16x32_bf16 v[60:63], v[80:83], v[128:131], v[60:63]
    v_add_f32_dpp v10, v51, v54 wave_ror:1 row_mask:0xf bank_mask:0xf
    s_nop 3
    v_add_f32_dpp v11, v55, v58 wave_ror:1 row_mask:0xf bank_mask:0xf
    v_mfma_f32_16x16x32_bf16 v[60:63], v[88:91], v[252:255], v[60:63]
    v_add_f32_dpp v10, v55, v54 wave_shr:1 row_mask:0xf bank_mask:0xf
    v_add_f32_dpp v11, v59, v58 wave_shr:1 row_mask:0xf bank_mask:0xf
    v_mfma_f32_16x16x32_bf16 v[60:63], v[96:99], v[248:251], v[60:63]
    v_add_f32_dpp v54, v15, v53 wave_ror:1 row_mask:0xf bank_mask:0xf
    v_add_f32_dpp v58, v10, v57 wave_ror:1 row_mask:0xf bank_mask:0xf
    v_mfma_f32_16x16x32_bf16 v[60:63], v[104:107], v[244:247], v[60:63]
    v_add_f32_dpp v54, v10, v53 wave_shr:1 row_mask:0xf bank_mask:0xf
    v_add_f32_dpp v58, v11, v57 wave_shr:1 row_mask:0xf bank_mask:0xf
    v_mfma_f32_16x16x32_bf16 v[60:63], v[112:115], v[240:243], v[60:63]
    v_add_f32_dpp v53, v50, v52 wave_ror:1 row_mask:0xf bank_mask:0xf
    v_add_f32_dpp v57, v54, v56 wave_ror:1 row_mask:0xf bank_mask:0xf
    v_mfma_f32_16x16x32_bf16 v[60:63], v[120:123], v[236:239], v[60:63]
    v_add_f32_dpp v53, v54, v52 wave_shr:1 row_mask:0xf bank_mask:0xf
    v_add_f32_dpp v57, v58, v56 wave_shr:1 row_mask:0xf bank_mask:0xf
    v_mfma_f32_16x16x32_bf16 v[60:63], v[132:135], v[232:235], v[60:63]
    ds_write_addtid_b32 v53 offset:44544
    ds_write_addtid_b32 v57 offset:44800
    v_mfma_f32_16x16x32_bf16 v[60:63], v[144:147], v[228:231], v[60:63]
    v_mfma_f32_16x16x32_bf16 v[60:63], v[156:159], v[224:227], v[60:63]
    v_mfma_f32_16x16x32_bf16 v[20:23], v[68:71], v[152:155], 0
    v_mfma_f32_16x16x32_bf16 v[20:23], v[76:79], v[140:143], v[20:23]
    s_waitcnt lgkmcnt(0)
    s_barrier
    v_mfma_f32_16x16x32_bf16 v[20:23], v[84:87], v[128:131], v[20:23]
    v_mfma_f32_16x16x32_bf16 v[20:23], v[92:95], v[252:255], v[20:23]
    v_mfma_f32_16x16x32_bf16 v[20:23], v[100:103], v[248:251], v[20:23]
    v_mfma_f32_16x16x32_bf16 v[20:23], v[108:111], v[244:247], v[20:23]
    v_mfma_f32_16x16x32_bf16 v[20:23], v[116:119], v[240:243], v[20:23]
    v_mfma_f32_16x16x32_bf16 v[20:23], v[124:127], v[236:239], v[20:23]
    v_mfma_f32_16x16x32_bf16 v[20:23], v[136:139], v[232:235], v[20:23]
    v_mfma_f32_16x16x32_bf16 v[20:23], v[148:151], v[228:231], v[20:23]
    v_mfma_f32_16x16x32_bf16 v[20:23], v[160:163], v[224:227], v[20:23]
    v_add_f32_dpp v12, v59, v62 wave_ror:1 row_mask:0xf bank_mask:0xf
    s_nop 6
    v_add_f32_dpp v13, v63, v22 wave_ror:1 row_mask:0xf bank_mask:0xf
    v_add_f32_dpp v12, v63, v62 wave_shr:1 row_mask:0xf bank_mask:0xf
    s_nop 0
    v_add_f32_dpp v13, v23, v22 wave_shr:1 row_mask:0xf bank_mask:0xf
    v_add_f32_dpp v62, v11, v61 wave_ror:1 row_mask:0xf bank_mask:0xf
    v_add_f32_dpp v22, v12, v21 wave_ror:1 row_mask:0xf bank_mask:0xf
    s_nop 0
    v_add_f32_dpp v62, v12, v61 wave_shr:1 row_mask:0xf bank_mask:0xf
    v_add_f32_dpp v22, v13, v21 wave_shr:1 row_mask:0xf bank_mask:0xf
    v_add_f32_dpp v61, v58, v60 wave_ror:1 row_mask:0xf bank_mask:0xf
    v_add_f32_dpp v21, v62, v20 wave_ror:1 row_mask:0xf bank_mask:0xf
    s_nop 0
    v_add_f32_dpp v61, v62, v60 wave_shr:1 row_mask:0xf bank_mask:0xf
    v_add_f32_dpp v21, v22, v20 wave_shr:1 row_mask:0xf bank_mask:0xf
    ds_write_addtid_b32 v61 offset:45056
    ds_write_addtid_b32 v21 offset:45312
    s_waitcnt lgkmcnt(0)
    s_barrier
    s_endpgm
.p2align 6
L_F:
    s_setprio 3
    s_lshl_b32 s33, s29, 8
    s_add_u32 s55, s33, 64512
    s_mov_b32 s46, 0x05040100
    s_mov_b32 s47, 0x07060302
    s_mov_b32 m0, s55
    v_pk_mul_f16 v104, v120, v136 op_sel:[0,0] op_sel_hi:[1,0]
    s_waitcnt vmcnt(6)
    v_perm_b32 v36, v228, v226, s46
    s_waitcnt lgkmcnt(7)
    v_mfma_f32_16x16x32_f16 v[176:179], v[144:147], v[112:115], v[176:179]
    v_pk_mul_f16 v105, v121, v137 op_sel:[0,0] op_sel_hi:[1,0]
    v_perm_b32 v37, v228, v226, s47
    v_pk_fma_f16 v104, v120, v136, v104 op_sel:[1,1,0] op_sel_hi:[0,1,1] neg_lo:[1,0,0]
    s_waitcnt lgkmcnt(6)
    v_mfma_f32_16x16x32_f16 v[184:187], v[160:163], v[112:115], v[184:187]
    v_perm_b32 v38, v229, v227, s46
    v_pk_fma_f16 v105, v121, v137, v105 op_sel:[1,1,0] op_sel_hi:[0,1,1] neg_lo:[1,0,0]
    v_pk_mul_f16 v106, v122, v138 op_sel:[0,0] op_sel_hi:[1,0]
    v_perm_b32 v39, v229, v227, s47
    s_waitcnt lgkmcnt(5)
    v_mfma_f32_16x16x32_f16 v[176:179], v[148:151], v[116:119], v[176:179]
    v_pk_mul_f16 v107, v123, v139 op_sel:[0,0] op_sel_hi:[1,0]
    ds_write_addtid_b32 v36 offset:40512
    v_pk_fma_f16 v106, v122, v138, v106 op_sel:[1,1,0] op_sel_hi:[0,1,1] neg_lo:[1,0,0]
    s_waitcnt lgkmcnt(5)
    v_mfma_f32_16x16x32_f16 v[184:187], v[164:167], v[116:119], v[184:187]
    ds_write_addtid_b32 v37 offset:44672
    v_pk_fma_f16 v107, v123, v139, v107 op_sel:[1,1,0] op_sel_hi:[0,1,1] neg_lo:[1,0,0]
    v_pk_mul_f16 v108, v124, v140 op_sel:[0,0] op_sel_hi:[1,0]
    ds_write_addtid_b32 v38 offset:48832
    s_waitcnt lgkmcnt(6)
    v_mfma_f32_16x16x32_f16 v[176:179], v[152:155], v[120:123], v[176:179]
    v_pk_mul_f16 v109, v125, v141 op_sel:[0,0] op_sel_hi:[1,0]
    ds_write_addtid_b32 v39 offset:52992
    v_pk_fma_f16 v108, v124, v140, v108 op_sel:[1,1,0] op_sel_hi:[0,1,1] neg_lo:[1,0,0]
    s_waitcnt lgkmcnt(6)
    v_mfma_f32_16x16x32_f16 v[184:187], v[168:171], v[120:123], v[184:187]
    s_waitcnt vmcnt(4)
    v_perm_b32 v40, v232, v230, s46
    v_pk_fma_f16 v109, v125, v141, v109 op_sel:[1,1,0] op_sel_hi:[0,1,1] neg_lo:[1,0,0]
    v_pk_mul_f16 v110, v126, v142 op_sel:[0,0] op_sel_hi:[1,0]
    v_perm_b32 v41, v232, v230, s47
    s_waitcnt lgkmcnt(5)
    v_mfma_f32_16x16x32_f16 v[176:179], v[156:159], v[124:127], v[176:179]
    v_pk_mul_f16 v111, v127, v143 op_sel:[0,0] op_sel_hi:[1,0]
    v_perm_b32 v42, v233, v231, s46
    v_pk_fma_f16 v110, v126, v142, v110 op_sel:[1,1,0] op_sel_hi:[0,1,1] neg_lo:[1,0,0]
    s_waitcnt lgkmcnt(4)
    v_mfma_f32_16x16x32_f16 v[184:187], v[172:175], v[124:127], v[184:187]
    v_perm_b32 v43, v233, v231, s47
    v_pk_fma_f16 v111, v127, v143, v111 op_sel:[1,1,0] op_sel_hi:[0,1,1] neg_lo:[1,0,0]
    v_mfma_f32_16x16x32_f16 v[180:183], v[144:147], v[96:99], v[180:183]
    ds_write_addtid_b32 v40 offset:41536
    v_mfma_f32_16x16x32_f16 v[188:191], v[160:163], v[96:99], v[188:191]
    v_mfma_f32_16x16x32_f16 v[180:183], v[148:151], v[100:103], v[180:183]
    ds_write_addtid_b32 v41 offset:45696
    v_mfma_f32_16x16x32_f16 v[188:191], v[164:167], v[100:103], v[188:191]
    v_mfma_f32_16x16x32_f16 v[180:183], v[152:155], v[104:107], v[180:183]
    ds_write_addtid_b32 v42 offset:49856
    v_mfma_f32_16x16x32_f16 v[188:191], v[168:171], v[104:107], v[188:191]
    v_mfma_f32_16x16x32_f16 v[180:183], v[156:159], v[108:111], v[180:183]
    ds_write_addtid_b32 v43 offset:54016
    v_mfma_f32_16x16x32_f16 v[188:191], v[172:175], v[108:111], v[188:191]
    v_mul_f32 v176, v18, v176
    v_mul_f32 v177, v18, v177
    s_nop 3
    v_mul_f32 v180, v18, v180
    v_mul_f32 v181, v18, v181
    v_mul_f32 v178, v18, v178
    v_mul_f32 v179, v18, v179
    v_mul_f32 v182, v18, v182
    v_mul_f32 v183, v18, v183
    v_mul_f32 v184, v18, v184
    v_mul_f32 v185, v18, v185
    v_mul_f32 v188, v18, v188
    v_mul_f32 v189, v18, v189
    v_mul_f32 v186, v18, v186
    v_add_u32 v3, s43, v3
    ds_write_b128 v3, v[176:179] offset:43008
    ds_write_b128 v3, v[180:183] offset:44032
    ds_write_b128 v3, v[184:187] offset:45056
    ds_write_b128 v3, v[188:191] offset:46080
    s_mov_b32 m0, s55
    s_waitcnt lgkmcnt(0)
    s_barrier
    s_setprio 2
    s_cmp_eq_u32 s31, 0
    s_cbranch_scc0 L_F1
    s_waitcnt vmcnt(2)
    v_perm_b32 v56, v236, v234, s46
    v_perm_b32 v57, v236, v234, s47
    v_perm_b32 v58, v237, v235, s46
    v_perm_b32 v59, v237, v235, s47
    ds_write_addtid_b32 v56 offset:42560
    ds_write_addtid_b32 v57 offset:46720
    ds_write_addtid_b32 v58 offset:50880
    ds_write_addtid_b32 v59 offset:55040
    s_waitcnt lgkmcnt(0)
    s_barrier
    s_lshl_b32 s50, s38, 16
    s_and_b32 s51, s38, 0xffff0000
    s_lshl_b32 s52, s39, 16
    s_and_b32 s53, s39, 0xffff0000
    v_mov_b32 v64, 0
    v_mov_b32 v65, 0
    v_mov_b32 v66, 0
    v_mov_b32 v67, 0
    s_waitcnt vmcnt(0)
    v_perm_b32 v56, v240, v238, s46
    v_perm_b32 v57, v240, v238, s47
    v_perm_b32 v58, v241, v239, s46
    v_perm_b32 v59, v241, v239, s47
    ds_write_addtid_b32 v56 offset:43584
    ds_write_addtid_b32 v57 offset:47744
    ds_write_addtid_b32 v58 offset:51904
    ds_write_addtid_b32 v59 offset:56064
    s_waitcnt lgkmcnt(0)
    s_barrier
    ds_read_u16_d16_hi v64, v30 offset:3200
    ds_read_u16_d16_hi v65, v30 offset:7360
    ds_read_u16_d16_hi v66, v30 offset:11520
    ds_read_u16_d16_hi v67, v30 offset:15680
    v_mov_b32 v68, 0
    v_mov_b32 v69, 0
    v_mov_b32 v70, 0
    v_mov_b32 v71, 0
    s_waitcnt lgkmcnt(3)
    v_mul_f32 v64, s50, v64
    s_waitcnt lgkmcnt(2)
    v_mul_f32 v65, s51, v65
    s_waitcnt lgkmcnt(1)
    v_mul_f32 v66, s52, v66
    s_waitcnt lgkmcnt(0)
    v_mul_f32 v67, s53, v67
    v_cvt_pk_bf16_f32 v64, 0, v64
    v_cvt_pk_bf16_f32 v65, 0, v65
    v_cvt_pk_bf16_f32 v66, 0, v66
    v_cvt_pk_bf16_f32 v67, 0, v67
    s_mov_b32 s33, 1261568
    s_barrier
    ds_read2st64_b32 v[44:45], v29 offset0:0 offset1:21
    ds_read2st64_b32 v[46:47], v29 offset0:42 offset1:63
    ds_read_u16_d16_hi v68, v30 offset:3712
    ds_read_u16_d16_hi v69, v30 offset:7872
    ds_read_u16_d16_hi v70, v30 offset:12032
    ds_read_u16_d16_hi v71, v30 offset:16192
    s_waitcnt lgkmcnt(5)
    v_cvt_pk_bf16_f32 v44, 0, v44
    v_cvt_pk_bf16_f32 v45, 0, v45
    s_waitcnt lgkmcnt(4)
    v_cvt_pk_bf16_f32 v46, 0, v46
    v_cvt_pk_bf16_f32 v47, 0, v47
    v_add_f32 v44, v44, v64
    v_add_f32 v45, v45, v65
    v_add_f32 v46, v46, v66
    v_add_f32 v47, v47, v67
    v_cvt_pk_bf16_f32 v48, v44, v45
    v_cvt_pk_bf16_f32 v49, v46, v47
    buffer_store_dwordx2 v[48:49], v31, s[24:27], s33 offen
    s_waitcnt lgkmcnt(3)
    v_mul_f32 v68, s50, v68
    s_waitcnt lgkmcnt(2)
    v_mul_f32 v69, s51, v69
    s_waitcnt lgkmcnt(1)
    v_mul_f32 v70, s52, v70
    s_waitcnt lgkmcnt(0)
    v_mul_f32 v71, s53, v71
    v_cvt_pk_bf16_f32 v68, 0, v68
    v_cvt_pk_bf16_f32 v69, 0, v69
    v_cvt_pk_bf16_f32 v70, 0, v70
    v_cvt_pk_bf16_f32 v71, 0, v71
    s_mov_b32 s33, 1490944
    s_cmp_lt_u32 s29, 2
    s_cselect_b32 s34, 0, 0x40000000
    v_add_u32 v42, s34, v31
    s_barrier
    ds_read2st64_b32 v[44:45], v29 offset0:4 offset1:25
    ds_read2st64_b32 v[46:47], v29 offset0:46 offset1:67
    ds_read_u16_d16_hi v64, v30 offset:3968
    ds_read_u16_d16_hi v65, v30 offset:8128
    ds_read_u16_d16_hi v66, v30 offset:12288
    ds_read_u16_d16_hi v67, v30 offset:16448
    s_waitcnt lgkmcnt(5)
    v_cvt_pk_bf16_f32 v44, 0, v44
    v_cvt_pk_bf16_f32 v45, 0, v45
    s_waitcnt lgkmcnt(4)
    v_cvt_pk_bf16_f32 v46, 0, v46
    v_cvt_pk_bf16_f32 v47, 0, v47
    v_add_f32 v44, v44, v68
    v_add_f32 v45, v45, v69
    v_add_f32 v46, v46, v70
    v_add_f32 v47, v47, v71
    v_cvt_pk_bf16_f32 v50, v44, v45
    v_cvt_pk_bf16_f32 v51, v46, v47
    buffer_store_dwordx2 v[50:51], v42, s[24:27], s33 offen
    s_waitcnt lgkmcnt(3)
    v_mul_f32 v64, s50, v64
    s_waitcnt lgkmcnt(2)
    v_mul_f32 v65, s51, v65
    s_waitcnt lgkmcnt(1)
    v_mul_f32 v66, s52, v66
    s_waitcnt lgkmcnt(0)
    v_mul_f32 v67, s53, v67
    v_cvt_pk_bf16_f32 v64, 0, v64
    v_cvt_pk_bf16_f32 v65, 0, v65
    v_cvt_pk_bf16_f32 v66, 0, v66
    v_cvt_pk_bf16_f32 v67, 0, v67
    s_mov_b32 s33, 1605632
    s_cmp_lt_u32 s29, 2
    s_cselect_b32 s34, 0, 0x40000000
    v_add_u32 v42, s34, v31
    s_barrier
    ds_read2st64_b32 v[44:45], v29 offset0:6 offset1:27
    ds_read2st64_b32 v[46:47], v29 offset0:48 offset1:69
    ds_read_u16_d16_hi v68, v30 offset:4224
    ds_read_u16_d16_hi v69, v30 offset:8384
    ds_read_u16_d16_hi v70, v30 offset:12544
    ds_read_u16_d16_hi v71, v30 offset:16704
    s_waitcnt lgkmcnt(5)
    v_cvt_pk_bf16_f32 v44, 0, v44
    v_cvt_pk_bf16_f32 v45, 0, v45
    s_waitcnt lgkmcnt(4)
    v_cvt_pk_bf16_f32 v46, 0, v46
    v_cvt_pk_bf16_f32 v47, 0, v47
    v_add_f32 v44, v44, v64
    v_add_f32 v45, v45, v65
    v_add_f32 v46, v46, v66
    v_add_f32 v47, v47, v67
    v_cvt_pk_bf16_f32 v48, v44, v45
    v_cvt_pk_bf16_f32 v49, v46, v47
    buffer_store_dwordx2 v[48:49], v42, s[24:27], s33 offen
    s_waitcnt lgkmcnt(3)
    v_mul_f32 v68, s50, v68
    s_waitcnt lgkmcnt(2)
    v_mul_f32 v69, s51, v69
    s_waitcnt lgkmcnt(1)
    v_mul_f32 v70, s52, v70
    s_waitcnt lgkmcnt(0)
    v_mul_f32 v71, s53, v71
    v_cvt_pk_bf16_f32 v68, 0, v68
    v_cvt_pk_bf16_f32 v69, 0, v69
    v_cvt_pk_bf16_f32 v70, 0, v70
    v_cvt_pk_bf16_f32 v71, 0, v71
    s_mov_b32 s33, 1720320
    s_cmp_lt_u32 s29, 2
    s_cselect_b32 s34, 0, 0x40000000
    v_add_u32 v42, s34, v31
    s_barrier
    ds_read2st64_b32 v[44:45], v29 offset0:8 offset1:29
    ds_read2st64_b32 v[46:47], v29 offset0:50 offset1:71
    s_waitcnt lgkmcnt(1)
    v_cvt_pk_bf16_f32 v44, 0, v44
    v_cvt_pk_bf16_f32 v45, 0, v45
    s_waitcnt lgkmcnt(0)
    v_cvt_pk_bf16_f32 v46, 0, v46
    v_cvt_pk_bf16_f32 v47, 0, v47
    v_add_f32 v44, v44, v68
    v_add_f32 v45, v45, v69
    v_add_f32 v46, v46, v70
    v_add_f32 v47, v47, v71
    v_cvt_pk_bf16_f32 v50, v44, v45
    v_cvt_pk_bf16_f32 v51, v46, v47
    buffer_store_dwordx2 v[50:51], v42, s[24:27], s33 offen
    s_endpgm
.p2align 6
L_F1:
    s_lshl_b32 s50, s38, 16
    s_and_b32 s51, s38, 0xffff0000
    s_lshl_b32 s52, s39, 16
    s_and_b32 s53, s39, 0xffff0000
    v_mov_b32 v64, 0
    v_mov_b32 v65, 0
    v_mov_b32 v66, 0
    v_mov_b32 v67, 0
    ds_read_u16_d16_hi v64, v30 offset:384
    ds_read_u16_d16_hi v65, v30 offset:4544
    ds_read_u16_d16_hi v66, v30 offset:8704
    ds_read_u16_d16_hi v67, v30 offset:12864
    v_mov_b32 v68, 0
    v_mov_b32 v69, 0
    v_mov_b32 v70, 0
    v_mov_b32 v71, 0
    s_waitcnt lgkmcnt(3)
    v_mul_f32 v64, s50, v64
    s_waitcnt lgkmcnt(2)
    v_mul_f32 v65, s51, v65
    s_waitcnt lgkmcnt(1)
    v_mul_f32 v66, s52, v66
    s_waitcnt lgkmcnt(0)
    v_mul_f32 v67, s53, v67
    v_cvt_pk_bf16_f32 v64, 0, v64
    v_cvt_pk_bf16_f32 v65, 0, v65
    v_cvt_pk_bf16_f32 v66, 0, v66
    v_cvt_pk_bf16_f32 v67, 0, v67
    s_waitcnt vmcnt(2)
    v_perm_b32 v56, v236, v234, s46
    v_perm_b32 v57, v236, v234, s47
    v_perm_b32 v58, v237, v235, s46
    v_perm_b32 v59, v237, v235, s47
    ds_write_addtid_b32 v56 offset:42560
    ds_write_addtid_b32 v57 offset:46720
    ds_write_addtid_b32 v58 offset:50880
    ds_write_addtid_b32 v59 offset:55040
    s_mov_b32 s33, 0
    s_waitcnt lgkmcnt(0)
    s_barrier
    ds_read2st64_b32 v[44:45], v29 offset0:0 offset1:21
    ds_read2st64_b32 v[46:47], v29 offset0:42 offset1:63
    ds_read_u16_d16_hi v68, v30 offset:896
    ds_read_u16_d16_hi v69, v30 offset:5056
    ds_read_u16_d16_hi v70, v30 offset:9216
    ds_read_u16_d16_hi v71, v30 offset:13376
    s_waitcnt lgkmcnt(5)
    v_cvt_pk_bf16_f32 v44, 0, v44
    v_cvt_pk_bf16_f32 v45, 0, v45
    s_waitcnt lgkmcnt(4)
    v_cvt_pk_bf16_f32 v46, 0, v46
    v_cvt_pk_bf16_f32 v47, 0, v47
    v_add_f32 v44, v44, v64
    v_add_f32 v45, v45, v65
    v_add_f32 v46, v46, v66
    v_add_f32 v47, v47, v67
    v_cvt_pk_bf16_f32 v48, v44, v45
    v_cvt_pk_bf16_f32 v49, v46, v47
    buffer_store_dwordx2 v[48:49], v31, s[24:27], s33 offen
    s_waitcnt lgkmcnt(3)
    v_mul_f32 v68, s50, v68
    s_waitcnt lgkmcnt(2)
    v_mul_f32 v69, s51, v69
    s_waitcnt lgkmcnt(1)
    v_mul_f32 v70, s52, v70
    s_waitcnt lgkmcnt(0)
    v_mul_f32 v71, s53, v71
    v_cvt_pk_bf16_f32 v68, 0, v68
    v_cvt_pk_bf16_f32 v69, 0, v69
    v_cvt_pk_bf16_f32 v70, 0, v70
    v_cvt_pk_bf16_f32 v71, 0, v71
    s_mov_b32 s33, 229376
    s_barrier
    ds_read2st64_b32 v[44:45], v29 offset0:4 offset1:25
    ds_read2st64_b32 v[46:47], v29 offset0:46 offset1:67
    ds_read_u16_d16_hi v64, v30 offset:1408
    ds_read_u16_d16_hi v65, v30 offset:5568
    ds_read_u16_d16_hi v66, v30 offset:9728
    ds_read_u16_d16_hi v67, v30 offset:13888
    s_waitcnt lgkmcnt(5)
    v_cvt_pk_bf16_f32 v44, 0, v44
    v_cvt_pk_bf16_f32 v45, 0, v45
    s_waitcnt lgkmcnt(4)
    v_cvt_pk_bf16_f32 v46, 0, v46
    v_cvt_pk_bf16_f32 v47, 0, v47
    v_add_f32 v44, v44, v68
    v_add_f32 v45, v45, v69
    v_add_f32 v46, v46, v70
    v_add_f32 v47, v47, v71
    v_cvt_pk_bf16_f32 v50, v44, v45
    v_cvt_pk_bf16_f32 v51, v46, v47
    buffer_store_dwordx2 v[50:51], v31, s[24:27], s33 offen
    s_waitcnt lgkmcnt(3)
    v_mul_f32 v64, s50, v64
    s_waitcnt lgkmcnt(2)
    v_mul_f32 v65, s51, v65
    s_waitcnt lgkmcnt(1)
    v_mul_f32 v66, s52, v66
    s_waitcnt lgkmcnt(0)
    v_mul_f32 v67, s53, v67
    v_cvt_pk_bf16_f32 v64, 0, v64
    v_cvt_pk_bf16_f32 v65, 0, v65
    v_cvt_pk_bf16_f32 v66, 0, v66
    v_cvt_pk_bf16_f32 v67, 0, v67
    s_mov_b32 s33, 458752
    s_barrier
    ds_read2st64_b32 v[44:45], v29 offset0:8 offset1:29
    ds_read2st64_b32 v[46:47], v29 offset0:50 offset1:71
    ds_read_u16_d16_hi v68, v30 offset:1920
    ds_read_u16_d16_hi v69, v30 offset:6080
    ds_read_u16_d16_hi v70, v30 offset:10240
    ds_read_u16_d16_hi v71, v30 offset:14400
    s_waitcnt lgkmcnt(5)
    v_cvt_pk_bf16_f32 v44, 0, v44
    v_cvt_pk_bf16_f32 v45, 0, v45
    s_waitcnt lgkmcnt(4)
    v_cvt_pk_bf16_f32 v46, 0, v46
    v_cvt_pk_bf16_f32 v47, 0, v47
    v_add_f32 v44, v44, v64
    v_add_f32 v45, v45, v65
    v_add_f32 v46, v46, v66
    v_add_f32 v47, v47, v67
    v_cvt_pk_bf16_f32 v48, v44, v45
    v_cvt_pk_bf16_f32 v49, v46, v47
    buffer_store_dwordx2 v[48:49], v31, s[24:27], s33 offen
    s_waitcnt lgkmcnt(3)
    v_mul_f32 v68, s50, v68
    s_waitcnt lgkmcnt(2)
    v_mul_f32 v69, s51, v69
    s_waitcnt lgkmcnt(1)
    v_mul_f32 v70, s52, v70
    s_waitcnt lgkmcnt(0)
    v_mul_f32 v71, s53, v71
    v_cvt_pk_bf16_f32 v68, 0, v68
    v_cvt_pk_bf16_f32 v69, 0, v69
    v_cvt_pk_bf16_f32 v70, 0, v70
    v_cvt_pk_bf16_f32 v71, 0, v71
    s_mov_b32 s33, 688128
    s_cmp_lt_u32 s29, 2
    s_cselect_b32 s34, 0, 0x40000000
    v_add_u32 v42, s34, v31
    s_barrier
    ds_read2st64_b32 v[44:45], v29 offset0:168 offset1:189
    ds_read2st64_b32 v[46:47], v29 offset0:210 offset1:231
    ds_read_u16_d16_hi v64, v30 offset:2176
    ds_read_u16_d16_hi v65, v30 offset:6336
    ds_read_u16_d16_hi v66, v30 offset:10496
    ds_read_u16_d16_hi v67, v30 offset:14656
    s_waitcnt lgkmcnt(5)
    v_cvt_pk_bf16_f32 v44, 0, v44
    v_cvt_pk_bf16_f32 v45, 0, v45
    s_waitcnt lgkmcnt(4)
    v_cvt_pk_bf16_f32 v46, 0, v46
    v_cvt_pk_bf16_f32 v47, 0, v47
    v_add_f32 v44, v44, v68
    v_add_f32 v45, v45, v69
    v_add_f32 v46, v46, v70
    v_add_f32 v47, v47, v71
    v_cvt_pk_bf16_f32 v50, v44, v45
    v_cvt_pk_bf16_f32 v51, v46, v47
    buffer_store_dwordx2 v[50:51], v42, s[24:27], s33 offen
    s_waitcnt lgkmcnt(3)
    v_mul_f32 v64, s50, v64
    s_waitcnt lgkmcnt(2)
    v_mul_f32 v65, s51, v65
    s_waitcnt lgkmcnt(1)
    v_mul_f32 v66, s52, v66
    s_waitcnt lgkmcnt(0)
    v_mul_f32 v67, s53, v67
    v_cvt_pk_bf16_f32 v64, 0, v64
    v_cvt_pk_bf16_f32 v65, 0, v65
    v_cvt_pk_bf16_f32 v66, 0, v66
    v_cvt_pk_bf16_f32 v67, 0, v67
    s_mov_b32 s33, 802816
    s_cmp_lt_u32 s29, 2
    s_cselect_b32 s34, 0, 0x40000000
    v_add_u32 v42, s34, v31
    s_barrier
    ds_read2st64_b32 v[44:45], v29 offset0:170 offset1:191
    ds_read2st64_b32 v[46:47], v29 offset0:212 offset1:233
    ds_read_u16_d16_hi v68, v30 offset:2432
    ds_read_u16_d16_hi v69, v30 offset:6592
    ds_read_u16_d16_hi v70, v30 offset:10752
    ds_read_u16_d16_hi v71, v30 offset:14912
    s_waitcnt lgkmcnt(5)
    v_cvt_pk_bf16_f32 v44, 0, v44
    v_cvt_pk_bf16_f32 v45, 0, v45
    s_waitcnt lgkmcnt(4)
    v_cvt_pk_bf16_f32 v46, 0, v46
    v_cvt_pk_bf16_f32 v47, 0, v47
    v_add_f32 v44, v44, v64
    v_add_f32 v45, v45, v65
    v_add_f32 v46, v46, v66
    v_add_f32 v47, v47, v67
    v_cvt_pk_bf16_f32 v48, v44, v45
    v_cvt_pk_bf16_f32 v49, v46, v47
    buffer_store_dwordx2 v[48:49], v42, s[24:27], s33 offen
    s_waitcnt lgkmcnt(3)
    v_mul_f32 v68, s50, v68
    s_waitcnt lgkmcnt(2)
    v_mul_f32 v69, s51, v69
    s_waitcnt lgkmcnt(1)
    v_mul_f32 v70, s52, v70
    s_waitcnt lgkmcnt(0)
    v_mul_f32 v71, s53, v71
    v_cvt_pk_bf16_f32 v68, 0, v68
    v_cvt_pk_bf16_f32 v69, 0, v69
    v_cvt_pk_bf16_f32 v70, 0, v70
    v_cvt_pk_bf16_f32 v71, 0, v71
    s_mov_b32 s33, 917504
    s_cmp_lt_u32 s29, 2
    s_cselect_b32 s34, 0, 0x40000000
    v_add_u32 v42, s34, v31
    s_barrier
    ds_read2st64_b32 v[44:45], v29 offset0:172 offset1:193
    ds_read2st64_b32 v[46:47], v29 offset0:214 offset1:235
    ds_read_u16_d16_hi v64, v30 offset:2688
    ds_read_u16_d16_hi v65, v30 offset:6848
    ds_read_u16_d16_hi v66, v30 offset:11008
    ds_read_u16_d16_hi v67, v30 offset:15168
    s_waitcnt lgkmcnt(5)
    v_cvt_pk_bf16_f32 v44, 0, v44
    v_cvt_pk_bf16_f32 v45, 0, v45
    s_waitcnt lgkmcnt(4)
    v_cvt_pk_bf16_f32 v46, 0, v46
    v_cvt_pk_bf16_f32 v47, 0, v47
    v_add_f32 v44, v44, v68
    v_add_f32 v45, v45, v69
    v_add_f32 v46, v46, v70
    v_add_f32 v47, v47, v71
    v_cvt_pk_bf16_f32 v50, v44, v45
    v_cvt_pk_bf16_f32 v51, v46, v47
    buffer_store_dwordx2 v[50:51], v42, s[24:27], s33 offen
    s_waitcnt lgkmcnt(3)
    v_mul_f32 v64, s50, v64
    s_waitcnt lgkmcnt(2)
    v_mul_f32 v65, s51, v65
    s_waitcnt lgkmcnt(1)
    v_mul_f32 v66, s52, v66
    s_waitcnt lgkmcnt(0)
    v_mul_f32 v67, s53, v67
    v_cvt_pk_bf16_f32 v64, 0, v64
    v_cvt_pk_bf16_f32 v65, 0, v65
    v_cvt_pk_bf16_f32 v66, 0, v66
    v_cvt_pk_bf16_f32 v67, 0, v67
    s_mov_b32 s33, 1032192
    s_cmp_lt_u32 s29, 2
    s_cselect_b32 s34, 0, 0x40000000
    v_add_u32 v42, s34, v31
    s_barrier
    ds_read2st64_b32 v[44:45], v29 offset0:174 offset1:195
    ds_read2st64_b32 v[46:47], v29 offset0:216 offset1:237
    ds_read_u16_d16_hi v68, v30 offset:2944
    ds_read_u16_d16_hi v69, v30 offset:7104
    ds_read_u16_d16_hi v70, v30 offset:11264
    ds_read_u16_d16_hi v71, v30 offset:15424
    s_waitcnt lgkmcnt(5)
    v_cvt_pk_bf16_f32 v44, 0, v44
    v_cvt_pk_bf16_f32 v45, 0, v45
    s_waitcnt lgkmcnt(4)
    v_cvt_pk_bf16_f32 v46, 0, v46
    v_cvt_pk_bf16_f32 v47, 0, v47
    v_add_f32 v44, v44, v64
    v_add_f32 v45, v45, v65
    v_add_f32 v46, v46, v66
    v_add_f32 v47, v47, v67
    v_cvt_pk_bf16_f32 v48, v44, v45
    v_cvt_pk_bf16_f32 v49, v46, v47
    buffer_store_dwordx2 v[48:49], v42, s[24:27], s33 offen
    s_waitcnt lgkmcnt(3)
    v_mul_f32 v68, s50, v68
    s_waitcnt lgkmcnt(2)
    v_mul_f32 v69, s51, v69
    s_waitcnt lgkmcnt(1)
    v_mul_f32 v70, s52, v70
    s_waitcnt lgkmcnt(0)
    v_mul_f32 v71, s53, v71
    v_cvt_pk_bf16_f32 v68, 0, v68
    v_cvt_pk_bf16_f32 v69, 0, v69
    v_cvt_pk_bf16_f32 v70, 0, v70
    v_cvt_pk_bf16_f32 v71, 0, v71
    s_mov_b32 s33, 1146880
    s_cmp_lt_u32 s29, 2
    s_cselect_b32 s34, 0, 0x40000000
    v_add_u32 v42, s34, v31
    s_barrier
    ds_read2st64_b32 v[44:45], v29 offset0:176 offset1:197
    ds_read2st64_b32 v[46:47], v29 offset0:218 offset1:239
    s_waitcnt lgkmcnt(1)
    v_cvt_pk_bf16_f32 v44, 0, v44
    v_cvt_pk_bf16_f32 v45, 0, v45
    s_waitcnt lgkmcnt(0)
    v_cvt_pk_bf16_f32 v46, 0, v46
    v_cvt_pk_bf16_f32 v47, 0, v47
    v_add_f32 v44, v44, v68
    v_add_f32 v45, v45, v69
    v_add_f32 v46, v46, v70
    v_add_f32 v47, v47, v71
    v_cvt_pk_bf16_f32 v50, v44, v45
    v_cvt_pk_bf16_f32 v51, v46, v47
    buffer_store_dwordx2 v[50:51], v42, s[24:27], s33 offen
    s_endpgm
.p2align 6
L_end:
    s_endpgm
.p2align 7
L_tab:
    .long 0xab30, 0xad50, 0x440, 0xa910
    .long 0x1210, 0xb900, 0x550, 0xa910
    .long 0xb7f0, 0xaf70, 0x660, 0xa910
    .long 0xb5d0, 0xaf70, 0x770, 0xa910
    .long 0xb2a0, 0xb190, 0x0, 0xa910
    .long 0xaa20, 0xa800, 0x110, 0xa910
    .long 0xb7f0, 0xaf70, 0x220, 0xa910
    .long 0xb5d0, 0xaf70, 0x330, 0xa910
    .long 0xb080, 0xba10, 0x880, 0xa910
    .long 0x1100, 0xbb20, 0x990, 0xa910
    .long 0xac40, 0xaf70, 0xaa0, 0xa910
    .long 0xb4c0, 0xaf70, 0xbb0, 0xa910
    .long 0xb6e0, 0xb3b0, 0xcc0, 0xa910
    .long 0xae60, 0x1320, 0xdd0, 0xa910
    .long 0xb5d0, 0xaf70, 0xee0, 0xa910
    .long 0xb7f0, 0xaf70, 0xff0, 0xa910
    .long 0xabb0, 0xadd0, 0x4c0, 0xa990
    .long 0x1290, 0xb980, 0x5d0, 0xa990
    .long 0xb870, 0xaff0, 0x6e0, 0xa990
    .long 0xb650, 0xaff0, 0x7f0, 0xa990
    .long 0xb320, 0xb210, 0x80, 0xa990
    .long 0xaaa0, 0xa880, 0x190, 0xa990
    .long 0xb870, 0xaff0, 0x2a0, 0xa990
    .long 0xb650, 0xaff0, 0x3b0, 0xa990
    .long 0xb100, 0xba90, 0x900, 0xa990
    .long 0x1180, 0xbba0, 0xa10, 0xa990
    .long 0xacc0, 0xaff0, 0xb20, 0xa990
    .long 0xb540, 0xaff0, 0xc30, 0xa990
    .long 0xb760, 0xb430, 0xd40, 0xa990
    .long 0xaee0, 0x13a0, 0xe50, 0xa990
    .long 0xb650, 0xaff0, 0xf60, 0xa990
    .long 0xb870, 0xaff0, 0x1070, 0xa990
    .long 0xab70, 0xad90, 0x480, 0xa950
    .long 0x1250, 0xb940, 0x590, 0xa950
    .long 0xb830, 0xafb0, 0x6a0, 0xa950
    .long 0xb610, 0xafb0, 0x7b0, 0xa950
    .long 0xb2e0, 0xb1d0, 0x40, 0xa950
    .long 0xaa60, 0xa840, 0x150, 0xa950
    .long 0xb830, 0xafb0, 0x260, 0xa950
    .long 0xb610, 0xafb0, 0x370, 0xa950
    .long 0xb0c0, 0xba50, 0x8c0, 0xa950
    .long 0x1140, 0xbb60, 0x9d0, 0xa950
    .long 0xac80, 0xafb0, 0xae0, 0xa950
    .long 0xb500, 0xafb0, 0xbf0, 0xa950
    .long 0xb720, 0xb3f0, 0xd00, 0xa950
    .long 0xaea0, 0x1360, 0xe10, 0xa950
    .long 0xb610, 0xafb0, 0xf20, 0xa950
    .long 0xb830, 0xafb0, 0x1030, 0xa950
    .long 0xabf0, 0xae10, 0x500, 0xa9d0
    .long 0x12d0, 0xb9c0, 0x610, 0xa9d0
    .long 0xb8b0, 0xb030, 0x720, 0xa9d0
    .long 0xb690, 0xb030, 0x830, 0xa9d0
    .long 0xb360, 0xb250, 0xc0, 0xa9d0
    .long 0xaae0, 0xa8c0, 0x1d0, 0xa9d0
    .long 0xb8b0, 0xb030, 0x2e0, 0xa9d0
    .long 0xb690, 0xb030, 0x3f0, 0xa9d0
    .long 0xb140, 0xbad0, 0x940, 0xa9d0
    .long 0x11c0, 0xbbe0, 0xa50, 0xa9d0
    .long 0xad00, 0xb030, 0xb60, 0xa9d0
    .long 0xb580, 0xb030, 0xc70, 0xa9d0
    .long 0xb7a0, 0xb470, 0xd80, 0xa9d0
    .long 0xaf20, 0x13e0, 0xe90, 0xa9d0
    .long 0xb690, 0xb030, 0xfa0, 0xa9d0
    .long 0xb8b0, 0xb030, 0x10b0, 0xa9d0
    .long 0x15048, 0x15000, 0x19b00, 0x0
    .long 0x154e8, 0x15004, 0x19b08, 0xffffffff
    .long 0x15988, 0x15008, 0x19b10, 0x0
    .long 0x15e28, 0x1500c, 0x19b18, 0xffffffff
    .long 0x15050, 0x15010, 0x19af8, 0x0
    .long 0x154f0, 0x15014, 0x19b00, 0xffffffff
    .long 0x15990, 0x15018, 0x19b08, 0x0
    .long 0x15e30, 0x1501c, 0x19b10, 0xffffffff
    .long 0x15058, 0x15020, 0x19af0, 0x0
    .long 0x154f8, 0x15024, 0x19af8, 0xffffffff
    .long 0x15998, 0x15028, 0x19b00, 0x0
    .long 0x15e38, 0x1502c, 0x19b08, 0xffffffff
    .long 0x15060, 0x15030, 0x19ae8, 0x0
    .long 0x15500, 0x15034, 0x19af0, 0xffffffff
    .long 0x159a0, 0x15038, 0x19af8, 0x0
    .long 0x15e40, 0x1503c, 0x19b00, 0xffffffff
    .long 0x15058, 0x15040, 0x19ac0, 0x0
    .long 0x154f8, 0x15044, 0x19ac8, 0xffffffff
    .long 0x15998, 0x15048, 0x19ad0, 0x0
    .long 0x15e38, 0x1504c, 0x19ad8, 0xffffffff
    .long 0x15060, 0x15050, 0x19ab8, 0x0
    .long 0x15500, 0x15054, 0x19ac0, 0xffffffff
    .long 0x159a0, 0x15058, 0x19ac8, 0x0
    .long 0x15e40, 0x1505c, 0x19ad0, 0xffffffff
    .long 0x15068, 0x15060, 0x19ab0, 0x0
    .long 0x15508, 0x15064, 0x19ab8, 0xffffffff
    .long 0x159a8, 0x15068, 0x19ac0, 0x0
    .long 0x15e48, 0x1506c, 0x19ac8, 0xffffffff
    .long 0x15070, 0x15070, 0x19aa8, 0x0
    .long 0x15510, 0x15074, 0x19ab0, 0xffffffff
    .long 0x159b0, 0x15078, 0x19ab8, 0x0
    .long 0x15e50, 0x1507c, 0x19ac0, 0xffffffff
    .long 0x15068, 0x15940, 0x19a80, 0x0
    .long 0x15508, 0x15944, 0x19a88, 0xffffffff
    .long 0x159a8, 0x15948, 0x19a90, 0x0
    .long 0x15e48, 0x1594c, 0x19a98, 0xffffffff
    .long 0x15070, 0x15950, 0x19a78, 0x0
    .long 0x15510, 0x15954, 0x19a80, 0xffffffff
    .long 0x159b0, 0x15958, 0x19a88, 0x0
    .long 0x15e50, 0x1595c, 0x19a90, 0xffffffff
    .long 0x15078, 0x15960, 0x19a70, 0x0
    .long 0x15518, 0x15964, 0x19a78, 0xffffffff
    .long 0x159b8, 0x15968, 0x19a80, 0x0
    .long 0x15e58, 0x1596c, 0x19a88, 0xffffffff
    .long 0x15080, 0x15970, 0x19a68, 0x0
    .long 0x15520, 0x15974, 0x19a70, 0xffffffff
    .long 0x159c0, 0x15978, 0x19a78, 0x0
    .long 0x15e60, 0x1597c, 0x19a80, 0xffffffff
    .long 0x15078, 0x15980, 0x19a40, 0x0
    .long 0x15518, 0x15984, 0x19a48, 0xffffffff
    .long 0x159b8, 0x15988, 0x19a50, 0x0
    .long 0x15e58, 0x1598c, 0x19a58, 0xffffffff
    .long 0x15080, 0x15990, 0x19a38, 0x0
    .long 0x15520, 0x15994, 0x19a40, 0xffffffff
    .long 0x159c0, 0x15998, 0x19a48, 0x0
    .long 0x15e60, 0x1599c, 0x19a50, 0xffffffff
    .long 0x15088, 0x159a0, 0x19a30, 0x0
    .long 0x15528, 0x159a4, 0x19a38, 0xffffffff
    .long 0x159c8, 0x159a8, 0x19a40, 0x0
    .long 0x15e68, 0x159ac, 0x19a48, 0xffffffff
    .long 0x15090, 0x159b0, 0x19a28, 0x0
    .long 0x15530, 0x159b4, 0x19a30, 0xffffffff
    .long 0x159d0, 0x159b8, 0x19a38, 0x0
    .long 0x15e70, 0x159bc, 0x19a40, 0xffffffff
    .fill 32, 4, 0
.section .rodata,"a"
.p2align 6
.amdhsa_kernel standalone__ssm_conv_s4d__prompt_kernel
  .amdhsa_next_free_vgpr 256
  .amdhsa_next_free_sgpr 102
  .amdhsa_accum_offset 256
  .amdhsa_group_segment_fixed_size 0
  .amdhsa_kernarg_size 80
  .amdhsa_user_sgpr_count 2
  .amdhsa_user_sgpr_kernarg_segment_ptr 1
  .amdhsa_system_sgpr_workgroup_id_x 1
  .amdhsa_float_denorm_mode_32 3
.end_amdhsa_kernel
```
